```python
import torch

def _softmax(x, axis=-1):
    return torch.softmax(x, dim=axis)
def _gelu(x):
    return torch.nn.functional.gelu(x, approximate="tanh")
def _silu(x):
    return torch.nn.functional.silu(x)
def _sigmoid(x):
    return torch.sigmoid(x)
def _layernorm(x, axis=-1, eps=1e-5):
    m = x.mean(dim=axis, keepdim=True)
    v = x.var(dim=axis, keepdim=True, unbiased=False)
    return (x - m) / torch.sqrt(v + eps)
def _scatter_add(tgt, idx, src, axis=0):
    return tgt.clone().index_add_(axis, idx, src)
def _segment_sum(src, seg, n):
    out = torch.zeros((n,) + src.shape[1:], dtype=src.dtype)
    return out.index_add_(0, seg, src)
def _pad(x, pw):
    flat = tuple(v for pair in reversed(pw) for v in pair)
    return torch.nn.functional.pad(x, flat)

kernel_name = 'sequential_preLN__gqa_block_cached__glu_gated_reglu__decode'

def setup_inputs():

    _w = (lambda a: (lambda t: t.to(torch.bfloat16) if t.is_floating_point() else t)(torch.as_tensor(a)))
    def _A_setup():
        B, Sq, D = 1, 1, 512
        Hq, Hkv, Sk, Dh = 32, 8, 65536, 128
        assert Hq % Hkv == 0, (Hq, Hkv)
        return {
            "x": _w((lambda *s: torch.randn(*s, dtype=torch.bfloat16) * 0.05)(B, Sq, D)),
            "k_cache": _w((lambda *s: torch.randn(*s, dtype=torch.bfloat16) * 3.2)(B, Hkv, Sk, Dh)),
            "v_cache": _w((lambda *s: torch.randn(*s, dtype=torch.bfloat16) * 1.6)(B, Hkv, Sk, Dh)),
            "wq": _w((lambda *s: torch.randn(*s, dtype=torch.bfloat16) * 3.2)(D, Hq * Dh) * (D ** -0.5)),
            "wo": _w((lambda *s: torch.randn(*s, dtype=torch.bfloat16) * 1.6)(Hq * Dh, D) * ((Hq * Dh) ** -0.5)),
        }
    _A_in = _A_setup()

    def _B_setup():
        B, S, D, F = 1, 1, 512, 1792
        return {
            "x": _w((lambda *s: torch.randn(*s, dtype=torch.bfloat16) * 0.05)(B, S, D)),
            "W_gate": _w((lambda *s: torch.randn(*s, dtype=torch.bfloat16) * 1.6)(D, F) * (2.0 / D) ** 0.5),
            "W_up": _w((lambda *s: torch.randn(*s, dtype=torch.bfloat16) * 1.6)(D, F) * (2.0 / D) ** 0.5),
            "W_down": _w((lambda *s: torch.randn(*s, dtype=torch.bfloat16) * 1.6)(F, D) * (1.0 / F) ** 0.5),
        }
    _B_in = _B_setup()

    return {
        "A_x": _A_in["x"],
        "A_k_cache": _A_in["k_cache"],
        "A_v_cache": _A_in["v_cache"],
        "A_wq": _A_in["wq"],
        "A_wo": _A_in["wo"],
        "B_x": _B_in["x"],
        "B_W_gate": _B_in["W_gate"],
        "B_W_up": _B_in["W_up"],
        "B_W_down": _B_in["W_down"],
    }

def reference(A_x, A_k_cache, A_v_cache, A_wq, A_wo, B_x, B_W_gate, B_W_up, B_W_down):
    def _A_ref(x, k_cache, v_cache, wq, wo):
        B, Sq, D = x.shape
        Hq, Dh = 32, 128
        Hkv = k_cache.shape[1]
        rep = Hq // Hkv
        q = (lambda x, *d: x.permute(*d))((x @ wq).reshape(B, Sq, Hq, Dh), 0, 2, 1, 3)
        k = (lambda x, n, axis: torch.repeat_interleave(x, n, dim=axis))(k_cache, rep, axis=1)
        v = (lambda x, n, axis: torch.repeat_interleave(x, n, dim=axis))(v_cache, rep, axis=1)
        scores = torch.einsum("bhqd,bhkd->bhqk", q, k) * (Dh ** -0.5)
        p = _softmax(scores, axis=-1)
        o = torch.einsum("bhqk,bhkd->bhqd", p, v)
        return (lambda x, *d: x.permute(*d))(o, 0, 2, 1, 3).reshape(B, Sq, Hq * Dh) @ wo

    def _B_ref(x, W_gate, W_up, W_down):
        gate = torch.einsum("bsd,df->bsf", x, W_gate)
        up = torch.einsum("bsd,df->bsf", x, W_up)
        gate = gate * (lambda x, dt: x.to(dt))(gate > 0, gate.dtype)
        h = gate * up
        return torch.einsum("bsf,fd->bsd", h, W_down)

    x = A_x
    h = x + _A_ref(_layernorm(x, axis=-1), A_k_cache, A_v_cache, A_wq, A_wo)
    h2 = h + _B_ref(_layernorm(h, axis=-1), B_W_gate, B_W_up, B_W_down)
    return h2
```

```asm
; @launch grid=(256,1,1) block=(256,1,1) lds=16384
.amdgcn_target "amdgcn-amd-amdhsa--gfx950"
.text
.globl sequential_preLN__gqa_block_cached__glu_gated_reglu__decode_kernel
.p2align 8
.type sequential_preLN__gqa_block_cached__glu_gated_reglu__decode_kernel,@function
sequential_preLN__gqa_block_cached__glu_gated_reglu__decode_kernel:
  s_cmp_ge_u32 s2, 256
  s_cbranch_scc1 L_end
  s_load_dwordx16 s[4:19], s[0:1], 0
  s_load_dwordx8 s[20:27], s[0:1], 64
  s_memrealtime vcc
  v_lshrrev_b32 v1, 6, v0
  v_and_b32 v0, 63, v0
  v_readfirstlane_b32 s3, v1
  s_and_b32 s28, s2, 7
  s_lshr_b32 s29, s2, 3
  v_lshlrev_b32 v2, 4, v0
  v_bfe_u32 v3, v0, 2, 2
  v_lshlrev_b32 v3, 8, v3
  v_lshrrev_b32 v1, 4, v0
  v_lshl_add_u32 v3, v1, 6, v3
  v_and_b32 v1, 3, v0
  v_lshl_add_u32 v3, v1, 4, v3
  v_lshrrev_b32 v13, 1, v0
  v_lshlrev_b32 v12, 14, v13
  v_and_b32 v1, 1, v0
  v_lshl_add_u32 v12, v1, 4, v12
  v_lshlrev_b32 v13, 2, v13
  v_and_b32 v14, 31, v0
  v_lshlrev_b32 v14, 3, v14
  v_lshrrev_b32 v1, 5, v0
  v_lshl_add_u32 v14, v1, 2, v14
  v_mov_b32 v8, -1
  v_mov_b32 v9, -1
  v_mov_b32 v10, -1
  v_mov_b32 v11, -1
  s_mov_b32 s74, 0x05040100
  s_mov_b32 s75, 0x07060302
  s_lshl_b32 s72, s29, 16
  s_lshl_b32 s73, s3, 10
  s_add_u32 s72, s72, s73
  s_lshl_b32 s79, s28, 24
  s_lshl_b32 s81, s28, 10
  s_lshl_b32 s82, s29, 5
  s_add_u32 s81, s81, s82
  s_lshl_b32 s82, s3, 20
  s_add_u32 s81, s81, s82
  s_lshl_b32 s82, s3, 8
  s_waitcnt lgkmcnt(0)
  s_load_dword s30, s[26:27], 0
  s_mov_b32 s14, vcc_lo
  s_mov_b32 s44, s4
  s_mov_b32 s45, s5
  s_mov_b32 s46, 1024
  s_mov_b32 s47, 0x20000
  v_lshrrev_b32 v13, 3, v0
  v_lshlrev_b32 v12, 15, v13
  v_and_b32 v1, 7, v0
  v_lshl_add_u32 v12, v1, 4, v12
  v_lshlrev_b32 v13, 3, v13
  s_lshl_b32 s81, s28, 10
  s_lshr_b32 s73, s29, 2
  s_lshl_b32 s73, s73, 7
  s_add_u32 s81, s81, s73
  s_and_b32 s73, s29, 3
  s_lshl_b32 s73, s73, 2
  s_add_u32 s73, s73, s3
  s_lshl_b32 s83, s73, 6
  s_lshl_b32 s73, s73, 18
  s_add_u32 s81, s81, s73
  s_mov_b32 s48, s10
  s_mov_b32 s49, s11
  s_mov_b32 s50, 4194304
  s_mov_b32 s51, 0x20000
  buffer_load_dwordx4 v[16:19], v2, s[44:47], 0 offen
  buffer_load_dwordx2 v[20:21], v13, s[44:47], s83 offen
  s_mov_b32 s24, s81
  s_add_u32 s73, s24, 0
  buffer_load_dwordx4 v[24:27], v12, s[48:51], s73 offen nt
  s_add_u32 s73, s24, 8192
  buffer_load_dwordx4 v[28:31], v12, s[48:51], s73 offen nt
  s_add_u32 s73, s24, 16384
  buffer_load_dwordx4 v[32:35], v12, s[48:51], s73 offen nt
  s_add_u32 s73, s24, 24576
  buffer_load_dwordx4 v[36:39], v12, s[48:51], s73 offen nt
  s_add_u32 s32, s6, s79
  s_addc_u32 s33, s7, 0
  s_mov_b32 s34, 16777216
  s_mov_b32 s35, 0x20000
  s_add_u32 s36, s8, s79
  s_addc_u32 s37, s9, 0
  s_mov_b32 s38, 16777216
  s_mov_b32 s39, 0x20000
  s_mov_b32 s40, s26
  s_mov_b32 s41, s27
  s_mov_b32 s42, 3145728
  s_mov_b32 s43, 0x20000
  s_add_u32 s73, s72, 0
  buffer_load_dwordx4 a[0:3], v3, s[32:35], s73 offen nt
  s_add_u32 s73, s72, 4096
  buffer_load_dwordx4 a[4:7], v3, s[32:35], s73 offen nt
  s_add_u32 s73, s72, 8192
  buffer_load_dwordx4 a[8:11], v3, s[32:35], s73 offen nt
  s_add_u32 s73, s72, 12288
  buffer_load_dwordx4 a[12:15], v3, s[32:35], s73 offen nt
  s_add_u32 s73, s72, 16384
  buffer_load_dwordx4 a[16:19], v3, s[32:35], s73 offen nt
  s_add_u32 s73, s72, 20480
  buffer_load_dwordx4 a[20:23], v3, s[32:35], s73 offen nt
  s_add_u32 s73, s72, 24576
  buffer_load_dwordx4 a[24:27], v3, s[32:35], s73 offen nt
  s_add_u32 s73, s72, 28672
  buffer_load_dwordx4 a[28:31], v3, s[32:35], s73 offen nt
  s_add_u32 s73, s72, 32768
  buffer_load_dwordx4 a[32:35], v3, s[32:35], s73 offen nt
  s_add_u32 s73, s72, 36864
  buffer_load_dwordx4 a[36:39], v3, s[32:35], s73 offen nt
  s_add_u32 s73, s72, 40960
  buffer_load_dwordx4 a[40:43], v3, s[32:35], s73 offen nt
  s_add_u32 s73, s72, 45056
  buffer_load_dwordx4 a[44:47], v3, s[32:35], s73 offen nt
  s_add_u32 s73, s72, 49152
  buffer_load_dwordx4 a[48:51], v3, s[32:35], s73 offen nt
  s_add_u32 s73, s72, 53248
  buffer_load_dwordx4 a[52:55], v3, s[32:35], s73 offen nt
  s_add_u32 s73, s72, 57344
  buffer_load_dwordx4 a[56:59], v3, s[32:35], s73 offen nt
  s_add_u32 s73, s72, 61440
  buffer_load_dwordx4 a[60:63], v3, s[32:35], s73 offen nt
  buffer_load_dword v4, v14, s[44:47], s82 offen
  s_lshl_b32 s81, s28, 16
  s_lshl_b32 s82, s29, 11
  s_add_u32 s81, s81, s82
  s_add_u32 s81, s81, 65536
  s_lshl_b32 s82, s2, 11
  s_add_u32 s82, s82, 1112064
  s_cmp_lt_u32 s3, 2
  s_cselect_b32 s81, s81, s82
  s_lshl_b32 s82, s3, 10
  s_add_u32 s81, s81, s82
  buffer_store_dwordx4 v[8:11], v2, s[40:43], s81 offen sc1
  s_lshl_b32 s80, s28, 12
  s_lshr_b32 s82, s29, 4
  s_lshl_b32 s82, s82, 11
  s_add_u32 s80, s80, s82
  s_and_b32 s82, s29, 15
  s_lshl_b32 s82, s82, 7
  s_add_u32 s80, s80, s82
  s_add_u32 s80, s80, 1048576
  s_mov_b64 exec, 0xff
  buffer_store_dwordx4 v[8:11], v2, s[40:43], s80 offen sc1
  s_mov_b64 exec, -1
  s_mov_b32 s52, s12
  s_mov_b32 s53, s13
  s_mov_b32 s54, 4194304
  s_mov_b32 s55, 0x20000
  s_mov_b32 s56, s16
  s_mov_b32 s57, s17
  s_mov_b32 s58, 0
  s_mov_b32 s59, 0x20000
  s_mov_b32 s60, s18
  s_mov_b32 s61, s19
  s_mov_b32 s62, 0
  s_mov_b32 s63, 0x20000
  s_mov_b32 s64, s20
  s_mov_b32 s65, s21
  s_mov_b32 s66, 0
  s_mov_b32 s67, 0x20000
  s_bfe_u32 s11, s29, 0x10002
  s_cmp_lg_u32 s11, 0
  s_cselect_b32 s54, s54, 0
  s_and_b32 s4, s29, 3
  s_or_b32 s12, s4, s11
  s_lshl_b32 s25, s28, 2
  s_lshr_b32 s82, s29, 3
  s_add_u32 s25, s25, s82
  s_mov_b32 s12, s4
  s_lshl_b32 s25, s28, 3
  s_lshr_b32 s82, s29, 2
  s_add_u32 s25, s25, s82
  s_bfe_u32 s81, s29, 0x10003
  s_lshl_b32 s81, s81, 2
  s_add_u32 s13, s81, s4
  s_lshl_b32 s80, s28, 12
  s_lshr_b32 s82, s29, 4
  s_lshl_b32 s82, s82, 11
  s_add_u32 s80, s80, s82
  s_lshl_b32 s82, s13, 8
  s_add_u32 s80, s80, s82
  s_add_u32 s80, s80, 1048576
  s_mov_b32 s68, s22
  s_mov_b32 s69, s23
  s_mov_b32 s70, 1024
  s_mov_b32 s71, 0x20000
  s_waitcnt vmcnt(9)
  s_add_u32 s73, s72, 2097152
  buffer_load_dwordx4 a[64:67], v3, s[32:35], s73 offen nt
  s_add_u32 s73, s72, 2101248
  buffer_load_dwordx4 a[68:71], v3, s[32:35], s73 offen nt
  s_add_u32 s73, s72, 2105344
  buffer_load_dwordx4 a[72:75], v3, s[32:35], s73 offen nt
  s_add_u32 s73, s72, 2109440
  buffer_load_dwordx4 a[76:79], v3, s[32:35], s73 offen nt
  s_add_u32 s73, s72, 2113536
  buffer_load_dwordx4 a[80:83], v3, s[32:35], s73 offen nt
  s_add_u32 s73, s72, 2117632
  buffer_load_dwordx4 a[84:87], v3, s[32:35], s73 offen nt
  s_add_u32 s73, s72, 2121728
  buffer_load_dwordx4 a[88:91], v3, s[32:35], s73 offen nt
  s_add_u32 s73, s72, 2125824
  buffer_load_dwordx4 a[92:95], v3, s[32:35], s73 offen nt
  v_lshlrev_b32 v48, 16, v16
  v_and_b32 v49, 0xffff0000, v16
  v_lshlrev_b32 v50, 16, v17
  v_and_b32 v51, 0xffff0000, v17
  v_lshlrev_b32 v52, 16, v18
  v_and_b32 v53, 0xffff0000, v18
  v_lshlrev_b32 v54, 16, v19
  v_and_b32 v55, 0xffff0000, v19
  v_add_f32 v56, v48, v49
  v_add_f32 v56, v56, v50
  v_add_f32 v56, v56, v51
  v_add_f32 v56, v56, v52
  v_add_f32 v56, v56, v53
  v_add_f32 v56, v56, v54
  v_add_f32 v56, v56, v55
  s_nop 1
  v_add_f32_dpp v56, v56, v56 row_ror:8 row_mask:0xf bank_mask:0xf
  s_nop 1
  v_add_f32_dpp v56, v56, v56 row_ror:4 row_mask:0xf bank_mask:0xf
  s_nop 1
  v_add_f32_dpp v56, v56, v56 row_ror:2 row_mask:0xf bank_mask:0xf
  s_nop 1
  v_add_f32_dpp v56, v56, v56 row_ror:1 row_mask:0xf bank_mask:0xf
  s_nop 1
  v_add_f32_dpp v56, v56, v56 row_bcast:15 row_mask:0xa bank_mask:0xf
  s_nop 1
  v_add_f32_dpp v56, v56, v56 row_bcast:31 row_mask:0xc bank_mask:0xf
  s_nop 0
  v_readlane_b32 s81, v56, 63
  v_mov_b32 v57, 0x3b000000
  s_nop 0
  v_mul_f32 v57, s81, v57
  v_sub_f32 v48, v48, v57
  v_sub_f32 v49, v49, v57
  v_sub_f32 v50, v50, v57
  v_sub_f32 v51, v51, v57
  v_sub_f32 v52, v52, v57
  v_sub_f32 v53, v53, v57
  v_sub_f32 v54, v54, v57
  v_sub_f32 v55, v55, v57
  v_mul_f32 v56, v48, v48
  v_fmac_f32 v56, v49, v49
  v_fmac_f32 v56, v50, v50
  v_fmac_f32 v56, v51, v51
  v_fmac_f32 v56, v52, v52
  v_fmac_f32 v56, v53, v53
  v_fmac_f32 v56, v54, v54
  v_fmac_f32 v56, v55, v55
  s_nop 1
  v_add_f32_dpp v56, v56, v56 row_ror:8 row_mask:0xf bank_mask:0xf
  s_nop 1
  v_add_f32_dpp v56, v56, v56 row_ror:4 row_mask:0xf bank_mask:0xf
  s_nop 1
  v_add_f32_dpp v56, v56, v56 row_ror:2 row_mask:0xf bank_mask:0xf
  s_nop 1
  v_add_f32_dpp v56, v56, v56 row_ror:1 row_mask:0xf bank_mask:0xf
  s_nop 1
  v_add_f32_dpp v56, v56, v56 row_bcast:15 row_mask:0xa bank_mask:0xf
  s_nop 1
  v_add_f32_dpp v56, v56, v56 row_bcast:31 row_mask:0xc bank_mask:0xf
  s_nop 0
  v_readlane_b32 s81, v56, 63
  v_mov_b32 v58, 0x3b000000
  s_nop 0
  v_mul_f32 v58, s81, v58
  v_cvt_pk_bf16_f32 v59, 0, v57
  v_cvt_pk_bf16_f32 v60, 0, v58
  v_add_f32 v60, 0x3727c5ac, v60
  v_cvt_pk_bf16_f32 v60, 0, v60
  v_sqrt_f32 v60, v60
  s_nop 0
  v_cvt_pk_bf16_f32 v60, 0, v60
  v_rcp_f32 v60, v60
  v_lshlrev_b32 v48, 16, v20
  v_and_b32 v49, 0xffff0000, v20
  v_sub_f32 v48, v48, v59
  v_sub_f32 v49, v49, v59
  v_cvt_pk_bf16_f32 v48, 0, v48
  v_cvt_pk_bf16_f32 v49, 0, v49
  v_mul_f32 v48, v48, v60
  v_mul_f32 v49, v49, v60
  v_cvt_pk_bf16_f32 v62, v48, v49
  v_lshlrev_b32 v50, 16, v21
  v_and_b32 v51, 0xffff0000, v21
  v_sub_f32 v50, v50, v59
  v_sub_f32 v51, v51, v59
  v_cvt_pk_bf16_f32 v50, 0, v50
  v_cvt_pk_bf16_f32 v51, 0, v51
  v_mul_f32 v50, v50, v60
  v_mul_f32 v51, v51, v60
  v_cvt_pk_bf16_f32 v63, v50, v51
  v_perm_b32 v80, v28, v24, s74
  v_perm_b32 v81, v28, v24, s75
  v_perm_b32 v82, v29, v25, s74
  v_perm_b32 v83, v29, v25, s75
  v_perm_b32 v84, v30, v26, s74
  v_perm_b32 v85, v30, v26, s75
  v_perm_b32 v86, v31, v27, s74
  v_perm_b32 v87, v31, v27, s75
  v_perm_b32 v88, v36, v32, s74
  v_perm_b32 v89, v36, v32, s75
  v_perm_b32 v90, v37, v33, s74
  v_perm_b32 v91, v37, v33, s75
  v_perm_b32 v92, v38, v34, s74
  v_perm_b32 v93, v38, v34, s75
  v_perm_b32 v94, v39, v35, s74
  v_perm_b32 v95, v39, v35, s75
  v_dot2_f32_bf16 v64, v80, v62, 0
  v_dot2_f32_bf16 v65, v81, v62, 0
  v_dot2_f32_bf16 v66, v82, v62, 0
  v_dot2_f32_bf16 v67, v83, v62, 0
  v_dot2_f32_bf16 v68, v84, v62, 0
  v_dot2_f32_bf16 v69, v85, v62, 0
  v_dot2_f32_bf16 v70, v86, v62, 0
  v_dot2_f32_bf16 v71, v87, v62, 0
  v_dot2_f32_bf16 v64, v88, v63, v64
  v_dot2_f32_bf16 v65, v89, v63, v65
  v_dot2_f32_bf16 v66, v90, v63, v66
  v_dot2_f32_bf16 v67, v91, v63, v67
  v_dot2_f32_bf16 v68, v92, v63, v68
  v_dot2_f32_bf16 v69, v93, v63, v69
  v_dot2_f32_bf16 v70, v94, v63, v70
  v_dot2_f32_bf16 v71, v95, v63, v71
  v_permlane32_swap_b32 v64, v68
  v_permlane32_swap_b32 v65, v69
  v_permlane32_swap_b32 v66, v70
  v_permlane32_swap_b32 v67, v71
  v_add_f32 v64, v64, v68
  v_add_f32 v65, v65, v69
  v_add_f32 v66, v66, v70
  v_add_f32 v67, v67, v71
  s_nop 0
  v_permlane16_swap_b32 v64, v66
  v_permlane16_swap_b32 v65, v67
  v_add_f32 v64, v64, v66
  v_add_f32 v65, v65, v67
  s_nop 0
  v_add_f32_dpp v66, v64, v64 row_ror:8 row_mask:0xf bank_mask:0x3
  v_add_f32_dpp v66, v65, v65 row_ror:8 row_mask:0xf bank_mask:0xc
  v_and_b32 v48, 7, v0
  v_lshlrev_b32 v48, 5, v48
  v_lshrrev_b32 v49, 3, v0
  v_lshl_add_u32 v48, v49, 2, v48
  s_lshl_b32 s81, s3, 8
  v_add_u32 v48, s81, v48
  v_mov_b32 v50, 0
  ds_write_b32 v48, v66 offset:1024
  s_mov_b64 exec, 1
  ds_write_b32 v50, v50 offset:256
  s_mov_b64 exec, -1
  s_waitcnt lgkmcnt(0)
  s_add_u32 s30, s30, 1
  s_and_b32 s31, s30, 0xff
  s_mul_i32 s31, s31, 0x01010101
  s_xor_b32 s31, s31, 0x33aa5500
  s_and_b32 s76, s31, 0xffff
  s_mul_i32 s77, s76, 0x10001
  s_getreg_b32 s15, hwreg(HW_REG_XCC_ID)
  s_lshl_b32 s15, s15, 16
  s_or_b32 s15, s15, s76
  s_barrier
  s_cmp_lg_u32 s3, 0
  s_cbranch_scc1 Lq_1
  v_lshlrev_b32 v60, 3, v0
  s_mov_b32 exec_hi, 0
  ds_read_b64 v[52:53], v60 offset:1024
  ds_read_b64 v[54:55], v60 offset:1280
  ds_read_b64 v[56:57], v60 offset:1536
  ds_read_b64 v[58:59], v60 offset:1792
  s_lshl_b32 s81, s28, 14
  s_lshr_b32 s82, s29, 3
  s_lshl_b32 s82, s82, 12
  s_add_u32 s81, s81, s82
  s_and_b32 s82, s29, 3
  s_lshl_b32 s82, s82, 10
  s_add_u32 s81, s81, s82
  s_and_b32 s82, s29, 4
  s_lshl_b32 s82, s82, 7
  s_add_u32 s81, s81, s82
  s_add_u32 s81, s81, 1703936
  s_waitcnt lgkmcnt(0)
  v_pk_add_f32 v[52:53], v[52:53], v[54:55]
  v_pk_add_f32 v[56:57], v[56:57], v[58:59]
  v_pk_add_f32 v[52:53], v[52:53], v[56:57]
  v_and_b32 v48, 0xffff0000, v52
  v_or_b32 v48, s76, v48
  v_lshl_or_b32 v49, v52, 16, s76
  v_and_b32 v50, 0xffff0000, v53
  v_or_b32 v50, s76, v50
  v_lshl_or_b32 v51, v53, 16, s76
  buffer_store_dwordx4 v[48:51], v2, s[40:43], s81 offen sc1
  s_mov_b64 exec, -1
Lq_1:
  s_waitcnt vmcnt(9)
  s_add_u32 s73, s72, 2129920
  buffer_load_dwordx4 a[96:99], v3, s[32:35], s73 offen nt
  s_add_u32 s73, s72, 2134016
  buffer_load_dwordx4 a[100:103], v3, s[32:35], s73 offen nt
  s_add_u32 s73, s72, 2138112
  buffer_load_dwordx4 a[104:107], v3, s[32:35], s73 offen nt
  s_add_u32 s73, s72, 2142208
  buffer_load_dwordx4 a[108:111], v3, s[32:35], s73 offen nt
  s_add_u32 s73, s72, 2146304
  buffer_load_dwordx4 a[112:115], v3, s[32:35], s73 offen nt
  s_add_u32 s73, s72, 2150400
  buffer_load_dwordx4 a[116:119], v3, s[32:35], s73 offen nt
  s_add_u32 s73, s72, 2154496
  buffer_load_dwordx4 a[120:123], v3, s[32:35], s73 offen nt
  s_add_u32 s73, s72, 2158592
  buffer_load_dwordx4 a[124:127], v3, s[32:35], s73 offen nt
  s_waitcnt vmcnt(8)
  s_add_u32 s73, s72, 4194304
  buffer_load_dwordx4 v[128:131], v3, s[32:35], s73 offen nt
  s_add_u32 s73, s72, 4198400
  buffer_load_dwordx4 v[132:135], v3, s[32:35], s73 offen nt
  s_add_u32 s73, s72, 4202496
  buffer_load_dwordx4 v[136:139], v3, s[32:35], s73 offen nt
  s_add_u32 s73, s72, 4206592
  buffer_load_dwordx4 v[140:143], v3, s[32:35], s73 offen nt
  s_add_u32 s73, s72, 4210688
  buffer_load_dwordx4 v[144:147], v3, s[32:35], s73 offen nt
  s_add_u32 s73, s72, 4214784
  buffer_load_dwordx4 v[148:151], v3, s[32:35], s73 offen nt
  s_add_u32 s73, s72, 4218880
  buffer_load_dwordx4 v[152:155], v3, s[32:35], s73 offen nt
  s_add_u32 s73, s72, 4222976
  buffer_load_dwordx4 v[156:159], v3, s[32:35], s73 offen nt
  s_waitcnt vmcnt(8)
  s_add_u32 s73, s72, 4227072
  buffer_load_dwordx4 v[160:163], v3, s[32:35], s73 offen nt
  s_add_u32 s73, s72, 4231168
  buffer_load_dwordx4 v[164:167], v3, s[32:35], s73 offen nt
  s_add_u32 s73, s72, 4235264
  buffer_load_dwordx4 v[168:171], v3, s[32:35], s73 offen nt
  s_add_u32 s73, s72, 4239360
  buffer_load_dwordx4 v[172:175], v3, s[32:35], s73 offen nt
  s_add_u32 s73, s72, 4243456
  buffer_load_dwordx4 v[176:179], v3, s[32:35], s73 offen nt
  s_add_u32 s73, s72, 4247552
  buffer_load_dwordx4 v[180:183], v3, s[32:35], s73 offen nt
  s_add_u32 s73, s72, 4251648
  buffer_load_dwordx4 v[184:187], v3, s[32:35], s73 offen nt
  s_add_u32 s73, s72, 4255744
  buffer_load_dwordx4 v[188:191], v3, s[32:35], s73 offen nt
  s_waitcnt vmcnt(8)
  s_add_u32 s73, s72, 6291456
  buffer_load_dwordx4 v[192:195], v3, s[32:35], s73 offen nt
  s_add_u32 s73, s72, 6295552
  buffer_load_dwordx4 v[196:199], v3, s[32:35], s73 offen nt
  s_add_u32 s73, s72, 6299648
  buffer_load_dwordx4 v[200:203], v3, s[32:35], s73 offen nt
  s_add_u32 s73, s72, 6303744
  buffer_load_dwordx4 v[204:207], v3, s[32:35], s73 offen nt
  s_add_u32 s73, s72, 6307840
  buffer_load_dwordx4 v[208:211], v3, s[32:35], s73 offen nt
  s_add_u32 s73, s72, 6311936
  buffer_load_dwordx4 v[212:215], v3, s[32:35], s73 offen nt
  s_add_u32 s73, s72, 6316032
  buffer_load_dwordx4 v[216:219], v3, s[32:35], s73 offen nt
  s_add_u32 s73, s72, 6320128
  buffer_load_dwordx4 v[220:223], v3, s[32:35], s73 offen nt
  v_and_b32 v122, 3, v0
  v_lshlrev_b32 v122, 8, v122
  v_lshrrev_b32 v1, 2, v0
  v_lshl_add_u32 v122, v1, 4, v122
  s_lshl_b32 s83, s28, 14
  s_lshl_b32 s82, s3, 12
  s_add_u32 s83, s83, s82
  s_add_u32 s83, s83, 1703936
  buffer_load_dwordx4 v[48:51], v2, s[40:43], s83 offen offset:0 sc1
  buffer_load_dwordx4 v[52:55], v2, s[40:43], s83 offen offset:1024 sc1
  buffer_load_dwordx4 v[56:59], v2, s[40:43], s83 offen offset:2048 sc1
  buffer_load_dwordx4 v[60:63], v2, s[40:43], s83 offen offset:3072 sc1
  s_waitcnt vmcnt(12)
  s_add_u32 s73, s72, 6324224
  buffer_load_dwordx4 v[224:227], v3, s[32:35], s73 offen nt
  s_add_u32 s73, s72, 6328320
  buffer_load_dwordx4 v[228:231], v3, s[32:35], s73 offen nt
  s_add_u32 s73, s72, 6332416
  buffer_load_dwordx4 v[232:235], v3, s[32:35], s73 offen nt
  s_add_u32 s73, s72, 6336512
  buffer_load_dwordx4 v[236:239], v3, s[32:35], s73 offen nt
  s_add_u32 s73, s72, 6340608
  buffer_load_dwordx4 v[240:243], v3, s[32:35], s73 offen nt
  s_add_u32 s73, s72, 6344704
  buffer_load_dwordx4 v[244:247], v3, s[32:35], s73 offen nt
  s_add_u32 s73, s72, 6348800
  buffer_load_dwordx4 v[248:251], v3, s[32:35], s73 offen nt
  s_add_u32 s73, s72, 6352896
  buffer_load_dwordx4 v[252:255], v3, s[32:35], s73 offen nt
  s_waitcnt vmcnt(12)
  s_add_u32 s73, s72, 8388608
  buffer_load_dwordx4 a[128:131], v3, s[32:35], s73 offen nt
  s_add_u32 s73, s72, 8392704
  buffer_load_dwordx4 a[132:135], v3, s[32:35], s73 offen nt
  s_add_u32 s73, s72, 8396800
  buffer_load_dwordx4 a[136:139], v3, s[32:35], s73 offen nt
  s_add_u32 s73, s72, 8400896
  buffer_load_dwordx4 a[140:143], v3, s[32:35], s73 offen nt
  s_add_u32 s73, s72, 8404992
  buffer_load_dwordx4 a[144:147], v3, s[32:35], s73 offen nt
  s_add_u32 s73, s72, 8409088
  buffer_load_dwordx4 a[148:151], v3, s[32:35], s73 offen nt
  s_add_u32 s73, s72, 8413184
  buffer_load_dwordx4 a[152:155], v3, s[32:35], s73 offen nt
  s_add_u32 s73, s72, 8417280
  buffer_load_dwordx4 a[156:159], v3, s[32:35], s73 offen nt
  s_waitcnt vmcnt(16)
  v_perm_b32 v64, v49, v48, s74
  v_perm_b32 v65, v51, v50, s74
  v_perm_b32 v66, v53, v52, s74
  v_perm_b32 v67, v55, v54, s74
  v_perm_b32 v68, v57, v56, s74
  v_perm_b32 v69, v59, v58, s74
  v_perm_b32 v70, v61, v60, s74
  v_perm_b32 v71, v63, v62, s74
  v_xor_b32 v64, s77, v64
  v_xor_b32 v65, s77, v65
  v_xor_b32 v66, s77, v66
  v_xor_b32 v67, s77, v67
  v_xor_b32 v68, s77, v68
  v_xor_b32 v69, s77, v69
  v_xor_b32 v70, s77, v70
  v_xor_b32 v71, s77, v71
  v_or3_b32 v64, v64, v65, v66
  v_or3_b32 v67, v67, v68, v69
  v_or3_b32 v64, v64, v70, v71
  v_or_b32 v64, v64, v67
  v_cmp_ne_u32 s[86:87], 0, v64
  s_nop 0
  s_mov_b64 s[84:85], s[86:87]
  s_cmp_eq_u64 s[84:85], 0
  s_cbranch_scc1 Lpd_2
  s_mov_b32 s78, 200000
Lpr_3:
  s_cmp_eq_u64 s[86:87], 0
  s_cbranch_scc1 Lps_4
  s_mov_b64 exec, s[86:87]
  buffer_load_dwordx4 v[48:51], v2, s[40:43], s83 offen offset:0 sc1
  buffer_load_dwordx4 v[52:55], v2, s[40:43], s83 offen offset:1024 sc1
  buffer_load_dwordx4 v[56:59], v2, s[40:43], s83 offen offset:2048 sc1
  buffer_load_dwordx4 v[60:63], v2, s[40:43], s83 offen offset:3072 sc1
Lps_4:
  s_mov_b64 exec, -1
  s_waitcnt vmcnt(0)
  s_cmp_eq_u64 s[86:87], 0
  s_cbranch_scc1 Lpc_5
  v_perm_b32 v64, v49, v48, s74
  v_perm_b32 v65, v51, v50, s74
  v_perm_b32 v66, v53, v52, s74
  v_perm_b32 v67, v55, v54, s74
  v_perm_b32 v68, v57, v56, s74
  v_perm_b32 v69, v59, v58, s74
  v_perm_b32 v70, v61, v60, s74
  v_perm_b32 v71, v63, v62, s74
  v_xor_b32 v64, s77, v64
  v_xor_b32 v65, s77, v65
  v_xor_b32 v66, s77, v66
  v_xor_b32 v67, s77, v67
  v_xor_b32 v68, s77, v68
  v_xor_b32 v69, s77, v69
  v_xor_b32 v70, s77, v70
  v_xor_b32 v71, s77, v71
  v_or3_b32 v64, v64, v65, v66
  v_or3_b32 v67, v67, v68, v69
  v_or3_b32 v64, v64, v70, v71
  v_or_b32 v64, v64, v67
  v_cmp_ne_u32 s[86:87], 0, v64
Lpc_5:
  s_nop 0
  s_mov_b64 s[84:85], s[86:87]
  s_cmp_eq_u64 s[84:85], 0
  s_cbranch_scc1 Lpd_2
  s_sub_u32 s78, s78, 1
  s_cmp_lg_u32 s78, 0
  s_cbranch_scc1 Lpr_3
Lpd_2:
  v_perm_b32 v64, v48, v49, s75
  v_perm_b32 v65, v50, v51, s75
  v_perm_b32 v66, v52, v53, s75
  v_perm_b32 v67, v54, v55, s75
  v_perm_b32 v68, v56, v57, s75
  v_perm_b32 v69, v58, v59, s75
  v_perm_b32 v70, v60, v61, s75
  v_perm_b32 v71, v62, v63, s75
  v_lshlrev_b32 v48, 2, v0
  s_lshl_b32 s82, s3, 8
  v_add_u32 v48, s82, v48
  v_pk_add_f32 v[64:65], v[64:65], v[66:67]
  v_pk_add_f32 v[68:69], v[68:69], v[70:71]
  v_pk_add_f32 v[64:65], v[64:65], v[68:69]
  v_cvt_pk_bf16_f32 v64, v64, v65
  ds_write_b32 v48, v64 offset:2048
  s_waitcnt lgkmcnt(0)
  s_barrier
  ds_read_b128 v[8:11], v122 offset:2048
  s_waitcnt lgkmcnt(0)
  v_mfma_f32_16x16x32_bf16 v[80:83], a[0:3], v[8:11], 0
  v_mfma_f32_16x16x32_bf16 v[84:87], a[4:7], v[8:11], 0
  v_mfma_f32_16x16x32_bf16 v[88:91], a[8:11], v[8:11], 0
  v_mfma_f32_16x16x32_bf16 v[92:95], a[12:15], v[8:11], 0
  s_nop 4
  v_add_f32_dpp v16, v81, v80 row_ror:12 row_mask:0xf bank_mask:0x1
  v_add_f32_dpp v16, v82, v16 row_ror:8 row_mask:0xf bank_mask:0x1
  v_add_f32_dpp v16, v83, v16 row_ror:4 row_mask:0xf bank_mask:0x1
  v_mfma_f32_16x16x32_bf16 v[80:83], a[16:19], v[8:11], 0
  v_add_f32_dpp v17, v85, v84 row_ror:12 row_mask:0xf bank_mask:0x1
  v_add_f32_dpp v17, v86, v17 row_ror:8 row_mask:0xf bank_mask:0x1
  v_add_f32_dpp v17, v87, v17 row_ror:4 row_mask:0xf bank_mask:0x1
  v_mfma_f32_16x16x32_bf16 v[84:87], a[20:23], v[8:11], 0
  v_add_f32_dpp v18, v89, v88 row_ror:12 row_mask:0xf bank_mask:0x1
  v_add_f32_dpp v18, v90, v18 row_ror:8 row_mask:0xf bank_mask:0x1
  v_add_f32_dpp v18, v91, v18 row_ror:4 row_mask:0xf bank_mask:0x1
  v_mfma_f32_16x16x32_bf16 v[88:91], a[24:27], v[8:11], 0
  v_add_f32_dpp v19, v93, v92 row_ror:12 row_mask:0xf bank_mask:0x1
  v_add_f32_dpp v19, v94, v19 row_ror:8 row_mask:0xf bank_mask:0x1
  v_add_f32_dpp v19, v95, v19 row_ror:4 row_mask:0xf bank_mask:0x1
  v_mfma_f32_16x16x32_bf16 v[92:95], a[28:31], v[8:11], 0
  v_add_f32_dpp v20, v81, v80 row_ror:12 row_mask:0xf bank_mask:0x1
  v_add_f32_dpp v20, v82, v20 row_ror:8 row_mask:0xf bank_mask:0x1
  v_add_f32_dpp v20, v83, v20 row_ror:4 row_mask:0xf bank_mask:0x1
  v_mfma_f32_16x16x32_bf16 v[80:83], a[32:35], v[8:11], 0
  v_add_f32_dpp v21, v85, v84 row_ror:12 row_mask:0xf bank_mask:0x1
  v_add_f32_dpp v21, v86, v21 row_ror:8 row_mask:0xf bank_mask:0x1
  v_add_f32_dpp v21, v87, v21 row_ror:4 row_mask:0xf bank_mask:0x1
  v_mfma_f32_16x16x32_bf16 v[84:87], a[36:39], v[8:11], 0
  v_add_f32_dpp v22, v89, v88 row_ror:12 row_mask:0xf bank_mask:0x1
  v_add_f32_dpp v22, v90, v22 row_ror:8 row_mask:0xf bank_mask:0x1
  v_add_f32_dpp v22, v91, v22 row_ror:4 row_mask:0xf bank_mask:0x1
  v_mfma_f32_16x16x32_bf16 v[88:91], a[40:43], v[8:11], 0
  v_add_f32_dpp v23, v93, v92 row_ror:12 row_mask:0xf bank_mask:0x1
  v_add_f32_dpp v23, v94, v23 row_ror:8 row_mask:0xf bank_mask:0x1
  v_add_f32_dpp v23, v95, v23 row_ror:4 row_mask:0xf bank_mask:0x1
  v_mfma_f32_16x16x32_bf16 v[92:95], a[44:47], v[8:11], 0
  v_add_f32_dpp v16, v82, v81 row_ror:12 row_mask:0xf bank_mask:0x2
  v_add_f32_dpp v16, v83, v16 row_ror:8 row_mask:0xf bank_mask:0x2
  v_add_f32_dpp v16, v80, v16 row_ror:4 row_mask:0xf bank_mask:0x2
  v_mfma_f32_16x16x32_bf16 v[80:83], a[48:51], v[8:11], 0
  v_add_f32_dpp v17, v86, v85 row_ror:12 row_mask:0xf bank_mask:0x2
  v_add_f32_dpp v17, v87, v17 row_ror:8 row_mask:0xf bank_mask:0x2
  v_add_f32_dpp v17, v84, v17 row_ror:4 row_mask:0xf bank_mask:0x2
  v_mfma_f32_16x16x32_bf16 v[84:87], a[52:55], v[8:11], 0
  v_add_f32_dpp v18, v90, v89 row_ror:12 row_mask:0xf bank_mask:0x2
  v_add_f32_dpp v18, v91, v18 row_ror:8 row_mask:0xf bank_mask:0x2
  v_add_f32_dpp v18, v88, v18 row_ror:4 row_mask:0xf bank_mask:0x2
  v_mfma_f32_16x16x32_bf16 v[88:91], a[56:59], v[8:11], 0
  v_add_f32_dpp v19, v94, v93 row_ror:12 row_mask:0xf bank_mask:0x2
  v_add_f32_dpp v19, v95, v19 row_ror:8 row_mask:0xf bank_mask:0x2
  v_add_f32_dpp v19, v92, v19 row_ror:4 row_mask:0xf bank_mask:0x2
  v_mfma_f32_16x16x32_bf16 v[92:95], a[60:63], v[8:11], 0
  v_add_f32_dpp v20, v82, v81 row_ror:12 row_mask:0xf bank_mask:0x2
  v_add_f32_dpp v20, v83, v20 row_ror:8 row_mask:0xf bank_mask:0x2
  v_add_f32_dpp v20, v80, v20 row_ror:4 row_mask:0xf bank_mask:0x2
  v_mfma_f32_16x16x32_bf16 v[80:83], a[64:67], v[8:11], 0
  v_add_f32_dpp v21, v86, v85 row_ror:12 row_mask:0xf bank_mask:0x2
  v_add_f32_dpp v21, v87, v21 row_ror:8 row_mask:0xf bank_mask:0x2
  v_add_f32_dpp v21, v84, v21 row_ror:4 row_mask:0xf bank_mask:0x2
  v_mfma_f32_16x16x32_bf16 v[84:87], a[68:71], v[8:11], 0
  v_add_f32_dpp v22, v90, v89 row_ror:12 row_mask:0xf bank_mask:0x2
  v_add_f32_dpp v22, v91, v22 row_ror:8 row_mask:0xf bank_mask:0x2
  v_add_f32_dpp v22, v88, v22 row_ror:4 row_mask:0xf bank_mask:0x2
  v_mfma_f32_16x16x32_bf16 v[88:91], a[72:75], v[8:11], 0
  v_add_f32_dpp v23, v94, v93 row_ror:12 row_mask:0xf bank_mask:0x2
  v_add_f32_dpp v23, v95, v23 row_ror:8 row_mask:0xf bank_mask:0x2
  v_add_f32_dpp v23, v92, v23 row_ror:4 row_mask:0xf bank_mask:0x2
  v_mfma_f32_16x16x32_bf16 v[92:95], a[76:79], v[8:11], 0
  v_add_f32_dpp v16, v83, v82 row_ror:12 row_mask:0xf bank_mask:0x4
  v_add_f32_dpp v16, v80, v16 row_ror:8 row_mask:0xf bank_mask:0x4
  v_add_f32_dpp v16, v81, v16 row_ror:4 row_mask:0xf bank_mask:0x4
  v_mfma_f32_16x16x32_bf16 v[80:83], a[80:83], v[8:11], 0
  v_add_f32_dpp v17, v87, v86 row_ror:12 row_mask:0xf bank_mask:0x4
  v_add_f32_dpp v17, v84, v17 row_ror:8 row_mask:0xf bank_mask:0x4
  v_add_f32_dpp v17, v85, v17 row_ror:4 row_mask:0xf bank_mask:0x4
  v_mfma_f32_16x16x32_bf16 v[84:87], a[84:87], v[8:11], 0
  v_add_f32_dpp v18, v91, v90 row_ror:12 row_mask:0xf bank_mask:0x4
  v_add_f32_dpp v18, v88, v18 row_ror:8 row_mask:0xf bank_mask:0x4
  v_add_f32_dpp v18, v89, v18 row_ror:4 row_mask:0xf bank_mask:0x4
  v_mfma_f32_16x16x32_bf16 v[88:91], a[88:91], v[8:11], 0
  v_add_f32_dpp v19, v95, v94 row_ror:12 row_mask:0xf bank_mask:0x4
  v_add_f32_dpp v19, v92, v19 row_ror:8 row_mask:0xf bank_mask:0x4
  v_add_f32_dpp v19, v93, v19 row_ror:4 row_mask:0xf bank_mask:0x4
  v_mfma_f32_16x16x32_bf16 v[92:95], a[92:95], v[8:11], 0
  v_add_f32_dpp v20, v83, v82 row_ror:12 row_mask:0xf bank_mask:0x4
  v_add_f32_dpp v20, v80, v20 row_ror:8 row_mask:0xf bank_mask:0x4
  v_add_f32_dpp v20, v81, v20 row_ror:4 row_mask:0xf bank_mask:0x4
  s_waitcnt vmcnt(8)
  s_add_u32 s73, s72, 8421376
  buffer_load_dwordx4 a[160:163], v3, s[32:35], s73 offen nt
  s_add_u32 s73, s72, 8425472
  buffer_load_dwordx4 a[164:167], v3, s[32:35], s73 offen nt
  s_add_u32 s73, s72, 8429568
  buffer_load_dwordx4 a[168:171], v3, s[32:35], s73 offen nt
  s_add_u32 s73, s72, 8433664
  buffer_load_dwordx4 a[172:175], v3, s[32:35], s73 offen nt
  s_add_u32 s73, s72, 8437760
  buffer_load_dwordx4 a[176:179], v3, s[32:35], s73 offen nt
  s_add_u32 s73, s72, 8441856
  buffer_load_dwordx4 a[180:183], v3, s[32:35], s73 offen nt
  s_add_u32 s73, s72, 8445952
  buffer_load_dwordx4 a[184:187], v3, s[32:35], s73 offen nt
  s_add_u32 s73, s72, 8450048
  buffer_load_dwordx4 a[188:191], v3, s[32:35], s73 offen nt
  v_mfma_f32_16x16x32_bf16 v[80:83], a[96:99], v[8:11], 0
  v_add_f32_dpp v21, v87, v86 row_ror:12 row_mask:0xf bank_mask:0x4
  v_add_f32_dpp v21, v84, v21 row_ror:8 row_mask:0xf bank_mask:0x4
  v_add_f32_dpp v21, v85, v21 row_ror:4 row_mask:0xf bank_mask:0x4
  v_mfma_f32_16x16x32_bf16 v[84:87], a[100:103], v[8:11], 0
  v_add_f32_dpp v22, v91, v90 row_ror:12 row_mask:0xf bank_mask:0x4
  v_add_f32_dpp v22, v88, v22 row_ror:8 row_mask:0xf bank_mask:0x4
  v_add_f32_dpp v22, v89, v22 row_ror:4 row_mask:0xf bank_mask:0x4
  v_mfma_f32_16x16x32_bf16 v[88:91], a[104:107], v[8:11], 0
  v_add_f32_dpp v23, v95, v94 row_ror:12 row_mask:0xf bank_mask:0x4
  v_add_f32_dpp v23, v92, v23 row_ror:8 row_mask:0xf bank_mask:0x4
  v_add_f32_dpp v23, v93, v23 row_ror:4 row_mask:0xf bank_mask:0x4
  v_mfma_f32_16x16x32_bf16 v[92:95], a[108:111], v[8:11], 0
  v_add_f32_dpp v16, v80, v83 row_ror:12 row_mask:0xf bank_mask:0x8
  v_add_f32_dpp v16, v81, v16 row_ror:8 row_mask:0xf bank_mask:0x8
  v_add_f32_dpp v16, v82, v16 row_ror:4 row_mask:0xf bank_mask:0x8
  v_mfma_f32_16x16x32_bf16 v[80:83], a[112:115], v[8:11], 0
  v_add_f32_dpp v17, v84, v87 row_ror:12 row_mask:0xf bank_mask:0x8
  v_add_f32_dpp v17, v85, v17 row_ror:8 row_mask:0xf bank_mask:0x8
  v_add_f32_dpp v17, v86, v17 row_ror:4 row_mask:0xf bank_mask:0x8
  v_mfma_f32_16x16x32_bf16 v[84:87], a[116:119], v[8:11], 0
  v_add_f32_dpp v18, v88, v91 row_ror:12 row_mask:0xf bank_mask:0x8
  v_add_f32_dpp v18, v89, v18 row_ror:8 row_mask:0xf bank_mask:0x8
  v_add_f32_dpp v18, v90, v18 row_ror:4 row_mask:0xf bank_mask:0x8
  v_mfma_f32_16x16x32_bf16 v[88:91], a[120:123], v[8:11], 0
  v_add_f32_dpp v19, v92, v95 row_ror:12 row_mask:0xf bank_mask:0x8
  v_add_f32_dpp v19, v93, v19 row_ror:8 row_mask:0xf bank_mask:0x8
  v_add_f32_dpp v19, v94, v19 row_ror:4 row_mask:0xf bank_mask:0x8
  v_mfma_f32_16x16x32_bf16 v[92:95], a[124:127], v[8:11], 0
  v_add_f32_dpp v20, v80, v83 row_ror:12 row_mask:0xf bank_mask:0x8
  v_add_f32_dpp v20, v81, v20 row_ror:8 row_mask:0xf bank_mask:0x8
  v_add_f32_dpp v20, v82, v20 row_ror:4 row_mask:0xf bank_mask:0x8
  v_mfma_f32_16x16x32_bf16 v[80:83], v[128:131], v[8:11], 0
  v_add_f32_dpp v21, v84, v87 row_ror:12 row_mask:0xf bank_mask:0x8
  v_add_f32_dpp v21, v85, v21 row_ror:8 row_mask:0xf bank_mask:0x8
  v_add_f32_dpp v21, v86, v21 row_ror:4 row_mask:0xf bank_mask:0x8
  v_mfma_f32_16x16x32_bf16 v[84:87], v[132:135], v[8:11], 0
  v_add_f32_dpp v22, v88, v91 row_ror:12 row_mask:0xf bank_mask:0x8
  v_add_f32_dpp v22, v89, v22 row_ror:8 row_mask:0xf bank_mask:0x8
  v_add_f32_dpp v22, v90, v22 row_ror:4 row_mask:0xf bank_mask:0x8
  v_mfma_f32_16x16x32_bf16 v[88:91], v[136:139], v[8:11], 0
  v_add_f32_dpp v23, v92, v95 row_ror:12 row_mask:0xf bank_mask:0x8
  v_add_f32_dpp v23, v93, v23 row_ror:8 row_mask:0xf bank_mask:0x8
  v_add_f32_dpp v23, v94, v23 row_ror:4 row_mask:0xf bank_mask:0x8
  v_cvt_pk_bf16_f32 v16, 0, v16
  v_cvt_pk_bf16_f32 v17, 0, v17
  v_cvt_pk_bf16_f32 v18, 0, v18
  v_cvt_pk_bf16_f32 v19, 0, v19
  v_cvt_pk_bf16_f32 v20, 0, v20
  v_cvt_pk_bf16_f32 v21, 0, v21
  v_cvt_pk_bf16_f32 v22, 0, v22
  v_cvt_pk_bf16_f32 v23, 0, v23
  v_mul_f32 v16, 0x3db504f3, v16
  v_mul_f32 v17, 0x3db504f3, v17
  v_mul_f32 v18, 0x3db504f3, v18
  v_mul_f32 v19, 0x3db504f3, v19
  v_mul_f32 v20, 0x3db504f3, v20
  v_mul_f32 v21, 0x3db504f3, v21
  v_mul_f32 v22, 0x3db504f3, v22
  v_mul_f32 v23, 0x3db504f3, v23
  v_cvt_pk_bf16_f32 v16, 0, v16
  v_cvt_pk_bf16_f32 v17, 0, v17
  v_cvt_pk_bf16_f32 v18, 0, v18
  v_cvt_pk_bf16_f32 v19, 0, v19
  v_cvt_pk_bf16_f32 v20, 0, v20
  v_cvt_pk_bf16_f32 v21, 0, v21
  v_cvt_pk_bf16_f32 v22, 0, v22
  v_cvt_pk_bf16_f32 v23, 0, v23
  v_max_f32 v5, v16, v17
  v_max3_f32 v5, v5, v18, v19
  v_max3_f32 v5, v5, v20, v21
  v_max3_f32 v5, v5, v22, v23
  v_mfma_f32_16x16x32_bf16 v[92:95], v[140:143], v[8:11], 0
  v_add_f32_dpp v24, v81, v80 row_ror:12 row_mask:0xf bank_mask:0x1
  v_add_f32_dpp v24, v82, v24 row_ror:8 row_mask:0xf bank_mask:0x1
  v_add_f32_dpp v24, v83, v24 row_ror:4 row_mask:0xf bank_mask:0x1
  v_mfma_f32_16x16x32_bf16 v[80:83], v[144:147], v[8:11], 0
  v_add_f32_dpp v25, v85, v84 row_ror:12 row_mask:0xf bank_mask:0x1
  v_add_f32_dpp v25, v86, v25 row_ror:8 row_mask:0xf bank_mask:0x1
  v_add_f32_dpp v25, v87, v25 row_ror:4 row_mask:0xf bank_mask:0x1
  v_mfma_f32_16x16x32_bf16 v[84:87], v[148:151], v[8:11], 0
  v_add_f32_dpp v26, v89, v88 row_ror:12 row_mask:0xf bank_mask:0x1
  v_add_f32_dpp v26, v90, v26 row_ror:8 row_mask:0xf bank_mask:0x1
  v_add_f32_dpp v26, v91, v26 row_ror:4 row_mask:0xf bank_mask:0x1
  v_mfma_f32_16x16x32_bf16 v[88:91], v[152:155], v[8:11], 0
  v_add_f32_dpp v27, v93, v92 row_ror:12 row_mask:0xf bank_mask:0x1
  v_add_f32_dpp v27, v94, v27 row_ror:8 row_mask:0xf bank_mask:0x1
  v_add_f32_dpp v27, v95, v27 row_ror:4 row_mask:0xf bank_mask:0x1
  v_mfma_f32_16x16x32_bf16 v[92:95], v[156:159], v[8:11], 0
  v_add_f32_dpp v28, v81, v80 row_ror:12 row_mask:0xf bank_mask:0x1
  v_add_f32_dpp v28, v82, v28 row_ror:8 row_mask:0xf bank_mask:0x1
  v_add_f32_dpp v28, v83, v28 row_ror:4 row_mask:0xf bank_mask:0x1
  v_mfma_f32_16x16x32_bf16 v[80:83], v[160:163], v[8:11], 0
  v_add_f32_dpp v29, v85, v84 row_ror:12 row_mask:0xf bank_mask:0x1
  v_add_f32_dpp v29, v86, v29 row_ror:8 row_mask:0xf bank_mask:0x1
  v_add_f32_dpp v29, v87, v29 row_ror:4 row_mask:0xf bank_mask:0x1
  v_mfma_f32_16x16x32_bf16 v[84:87], v[164:167], v[8:11], 0
  v_add_f32_dpp v30, v89, v88 row_ror:12 row_mask:0xf bank_mask:0x1
  v_add_f32_dpp v30, v90, v30 row_ror:8 row_mask:0xf bank_mask:0x1
  v_add_f32_dpp v30, v91, v30 row_ror:4 row_mask:0xf bank_mask:0x1
  v_mfma_f32_16x16x32_bf16 v[88:91], v[168:171], v[8:11], 0
  v_add_f32_dpp v31, v93, v92 row_ror:12 row_mask:0xf bank_mask:0x1
  v_add_f32_dpp v31, v94, v31 row_ror:8 row_mask:0xf bank_mask:0x1
  v_add_f32_dpp v31, v95, v31 row_ror:4 row_mask:0xf bank_mask:0x1
  v_mfma_f32_16x16x32_bf16 v[92:95], v[172:175], v[8:11], 0
  v_add_f32_dpp v24, v82, v81 row_ror:12 row_mask:0xf bank_mask:0x2
  v_add_f32_dpp v24, v83, v24 row_ror:8 row_mask:0xf bank_mask:0x2
  v_add_f32_dpp v24, v80, v24 row_ror:4 row_mask:0xf bank_mask:0x2
  v_mfma_f32_16x16x32_bf16 v[80:83], v[176:179], v[8:11], 0
  v_add_f32_dpp v25, v86, v85 row_ror:12 row_mask:0xf bank_mask:0x2
  v_add_f32_dpp v25, v87, v25 row_ror:8 row_mask:0xf bank_mask:0x2
  v_add_f32_dpp v25, v84, v25 row_ror:4 row_mask:0xf bank_mask:0x2
  v_mfma_f32_16x16x32_bf16 v[84:87], v[180:183], v[8:11], 0
  v_add_f32_dpp v26, v90, v89 row_ror:12 row_mask:0xf bank_mask:0x2
  v_add_f32_dpp v26, v91, v26 row_ror:8 row_mask:0xf bank_mask:0x2
  v_add_f32_dpp v26, v88, v26 row_ror:4 row_mask:0xf bank_mask:0x2
  v_mfma_f32_16x16x32_bf16 v[88:91], v[184:187], v[8:11], 0
  v_add_f32_dpp v27, v94, v93 row_ror:12 row_mask:0xf bank_mask:0x2
  v_add_f32_dpp v27, v95, v27 row_ror:8 row_mask:0xf bank_mask:0x2
  v_add_f32_dpp v27, v92, v27 row_ror:4 row_mask:0xf bank_mask:0x2
  v_mfma_f32_16x16x32_bf16 v[92:95], v[188:191], v[8:11], 0
  v_add_f32_dpp v28, v82, v81 row_ror:12 row_mask:0xf bank_mask:0x2
  v_add_f32_dpp v28, v83, v28 row_ror:8 row_mask:0xf bank_mask:0x2
  v_add_f32_dpp v28, v80, v28 row_ror:4 row_mask:0xf bank_mask:0x2
  s_waitcnt vmcnt(8)
  s_add_u32 s73, s72, 10485760
  buffer_load_dwordx4 a[192:195], v3, s[32:35], s73 offen nt
  s_add_u32 s73, s72, 10489856
  buffer_load_dwordx4 a[196:199], v3, s[32:35], s73 offen nt
  s_add_u32 s73, s72, 10493952
  buffer_load_dwordx4 a[200:203], v3, s[32:35], s73 offen nt
  s_add_u32 s73, s72, 10498048
  buffer_load_dwordx4 a[204:207], v3, s[32:35], s73 offen nt
  s_add_u32 s73, s72, 10502144
  buffer_load_dwordx4 a[208:211], v3, s[32:35], s73 offen nt
  s_add_u32 s73, s72, 10506240
  buffer_load_dwordx4 a[212:215], v3, s[32:35], s73 offen nt
  s_add_u32 s73, s72, 10510336
  buffer_load_dwordx4 a[216:219], v3, s[32:35], s73 offen nt
  s_add_u32 s73, s72, 10514432
  buffer_load_dwordx4 a[220:223], v3, s[32:35], s73 offen nt
  v_mfma_f32_16x16x32_bf16 v[80:83], v[192:195], v[8:11], 0
  v_add_f32_dpp v29, v86, v85 row_ror:12 row_mask:0xf bank_mask:0x2
  v_add_f32_dpp v29, v87, v29 row_ror:8 row_mask:0xf bank_mask:0x2
  v_add_f32_dpp v29, v84, v29 row_ror:4 row_mask:0xf bank_mask:0x2
  v_mfma_f32_16x16x32_bf16 v[84:87], v[196:199], v[8:11], 0
  v_add_f32_dpp v30, v90, v89 row_ror:12 row_mask:0xf bank_mask:0x2
  v_add_f32_dpp v30, v91, v30 row_ror:8 row_mask:0xf bank_mask:0x2
  v_add_f32_dpp v30, v88, v30 row_ror:4 row_mask:0xf bank_mask:0x2
  v_mfma_f32_16x16x32_bf16 v[88:91], v[200:203], v[8:11], 0
  v_add_f32_dpp v31, v94, v93 row_ror:12 row_mask:0xf bank_mask:0x2
  v_add_f32_dpp v31, v95, v31 row_ror:8 row_mask:0xf bank_mask:0x2
  v_add_f32_dpp v31, v92, v31 row_ror:4 row_mask:0xf bank_mask:0x2
  v_mfma_f32_16x16x32_bf16 v[92:95], v[204:207], v[8:11], 0
  v_add_f32_dpp v24, v83, v82 row_ror:12 row_mask:0xf bank_mask:0x4
  v_add_f32_dpp v24, v80, v24 row_ror:8 row_mask:0xf bank_mask:0x4
  v_add_f32_dpp v24, v81, v24 row_ror:4 row_mask:0xf bank_mask:0x4
  v_mfma_f32_16x16x32_bf16 v[80:83], v[208:211], v[8:11], 0
  v_add_f32_dpp v25, v87, v86 row_ror:12 row_mask:0xf bank_mask:0x4
  v_add_f32_dpp v25, v84, v25 row_ror:8 row_mask:0xf bank_mask:0x4
  v_add_f32_dpp v25, v85, v25 row_ror:4 row_mask:0xf bank_mask:0x4
  v_mfma_f32_16x16x32_bf16 v[84:87], v[212:215], v[8:11], 0
  v_add_f32_dpp v26, v91, v90 row_ror:12 row_mask:0xf bank_mask:0x4
  v_add_f32_dpp v26, v88, v26 row_ror:8 row_mask:0xf bank_mask:0x4
  v_add_f32_dpp v26, v89, v26 row_ror:4 row_mask:0xf bank_mask:0x4
  v_mfma_f32_16x16x32_bf16 v[88:91], v[216:219], v[8:11], 0
  v_add_f32_dpp v27, v95, v94 row_ror:12 row_mask:0xf bank_mask:0x4
  v_add_f32_dpp v27, v92, v27 row_ror:8 row_mask:0xf bank_mask:0x4
  v_add_f32_dpp v27, v93, v27 row_ror:4 row_mask:0xf bank_mask:0x4
  v_mfma_f32_16x16x32_bf16 v[92:95], v[220:223], v[8:11], 0
  v_add_f32_dpp v28, v83, v82 row_ror:12 row_mask:0xf bank_mask:0x4
  v_add_f32_dpp v28, v80, v28 row_ror:8 row_mask:0xf bank_mask:0x4
  v_add_f32_dpp v28, v81, v28 row_ror:4 row_mask:0xf bank_mask:0x4
  v_mfma_f32_16x16x32_bf16 v[80:83], v[224:227], v[8:11], 0
  v_add_f32_dpp v29, v87, v86 row_ror:12 row_mask:0xf bank_mask:0x4
  v_add_f32_dpp v29, v84, v29 row_ror:8 row_mask:0xf bank_mask:0x4
  v_add_f32_dpp v29, v85, v29 row_ror:4 row_mask:0xf bank_mask:0x4
  v_mfma_f32_16x16x32_bf16 v[84:87], v[228:231], v[8:11], 0
  v_add_f32_dpp v30, v91, v90 row_ror:12 row_mask:0xf bank_mask:0x4
  v_add_f32_dpp v30, v88, v30 row_ror:8 row_mask:0xf bank_mask:0x4
  v_add_f32_dpp v30, v89, v30 row_ror:4 row_mask:0xf bank_mask:0x4
  v_mfma_f32_16x16x32_bf16 v[88:91], v[232:235], v[8:11], 0
  v_add_f32_dpp v31, v95, v94 row_ror:12 row_mask:0xf bank_mask:0x4
  v_add_f32_dpp v31, v92, v31 row_ror:8 row_mask:0xf bank_mask:0x4
  v_add_f32_dpp v31, v93, v31 row_ror:4 row_mask:0xf bank_mask:0x4
  v_mfma_f32_16x16x32_bf16 v[92:95], v[236:239], v[8:11], 0
  v_add_f32_dpp v24, v80, v83 row_ror:12 row_mask:0xf bank_mask:0x8
  v_add_f32_dpp v24, v81, v24 row_ror:8 row_mask:0xf bank_mask:0x8
  v_add_f32_dpp v24, v82, v24 row_ror:4 row_mask:0xf bank_mask:0x8
  v_mfma_f32_16x16x32_bf16 v[80:83], v[240:243], v[8:11], 0
  v_add_f32_dpp v25, v84, v87 row_ror:12 row_mask:0xf bank_mask:0x8
  v_add_f32_dpp v25, v85, v25 row_ror:8 row_mask:0xf bank_mask:0x8
  v_add_f32_dpp v25, v86, v25 row_ror:4 row_mask:0xf bank_mask:0x8
  v_mfma_f32_16x16x32_bf16 v[84:87], v[244:247], v[8:11], 0
  v_add_f32_dpp v26, v88, v91 row_ror:12 row_mask:0xf bank_mask:0x8
  v_add_f32_dpp v26, v89, v26 row_ror:8 row_mask:0xf bank_mask:0x8
  v_add_f32_dpp v26, v90, v26 row_ror:4 row_mask:0xf bank_mask:0x8
  v_mfma_f32_16x16x32_bf16 v[88:91], v[248:251], v[8:11], 0
  v_add_f32_dpp v27, v92, v95 row_ror:12 row_mask:0xf bank_mask:0x8
  v_add_f32_dpp v27, v93, v27 row_ror:8 row_mask:0xf bank_mask:0x8
  v_add_f32_dpp v27, v94, v27 row_ror:4 row_mask:0xf bank_mask:0x8
  v_mfma_f32_16x16x32_bf16 v[92:95], v[252:255], v[8:11], 0
  v_add_f32_dpp v28, v80, v83 row_ror:12 row_mask:0xf bank_mask:0x8
  v_add_f32_dpp v28, v81, v28 row_ror:8 row_mask:0xf bank_mask:0x8
  v_add_f32_dpp v28, v82, v28 row_ror:4 row_mask:0xf bank_mask:0x8
  v_mfma_f32_16x16x32_bf16 v[80:83], a[128:131], v[8:11], 0
  v_add_f32_dpp v29, v84, v87 row_ror:12 row_mask:0xf bank_mask:0x8
  v_add_f32_dpp v29, v85, v29 row_ror:8 row_mask:0xf bank_mask:0x8
  v_add_f32_dpp v29, v86, v29 row_ror:4 row_mask:0xf bank_mask:0x8
  v_mfma_f32_16x16x32_bf16 v[84:87], a[132:135], v[8:11], 0
  v_add_f32_dpp v30, v88, v91 row_ror:12 row_mask:0xf bank_mask:0x8
  v_add_f32_dpp v30, v89, v30 row_ror:8 row_mask:0xf bank_mask:0x8
  v_add_f32_dpp v30, v90, v30 row_ror:4 row_mask:0xf bank_mask:0x8
  v_mfma_f32_16x16x32_bf16 v[88:91], a[136:139], v[8:11], 0
  v_add_f32_dpp v31, v92, v95 row_ror:12 row_mask:0xf bank_mask:0x8
  v_add_f32_dpp v31, v93, v31 row_ror:8 row_mask:0xf bank_mask:0x8
  v_add_f32_dpp v31, v94, v31 row_ror:4 row_mask:0xf bank_mask:0x8
  v_cvt_pk_bf16_f32 v24, 0, v24
  v_cvt_pk_bf16_f32 v25, 0, v25
  v_cvt_pk_bf16_f32 v26, 0, v26
  v_cvt_pk_bf16_f32 v27, 0, v27
  v_cvt_pk_bf16_f32 v28, 0, v28
  v_cvt_pk_bf16_f32 v29, 0, v29
  v_cvt_pk_bf16_f32 v30, 0, v30
  v_cvt_pk_bf16_f32 v31, 0, v31
  v_mul_f32 v24, 0x3db504f3, v24
  v_mul_f32 v25, 0x3db504f3, v25
  v_mul_f32 v26, 0x3db504f3, v26
  v_mul_f32 v27, 0x3db504f3, v27
  v_mul_f32 v28, 0x3db504f3, v28
  v_mul_f32 v29, 0x3db504f3, v29
  v_mul_f32 v30, 0x3db504f3, v30
  v_mul_f32 v31, 0x3db504f3, v31
  v_cvt_pk_bf16_f32 v24, 0, v24
  v_cvt_pk_bf16_f32 v25, 0, v25
  v_cvt_pk_bf16_f32 v26, 0, v26
  v_cvt_pk_bf16_f32 v27, 0, v27
  v_cvt_pk_bf16_f32 v28, 0, v28
  v_cvt_pk_bf16_f32 v29, 0, v29
  v_cvt_pk_bf16_f32 v30, 0, v30
  v_cvt_pk_bf16_f32 v31, 0, v31
  v_max3_f32 v5, v5, v24, v25
  v_max3_f32 v5, v5, v26, v27
  v_max3_f32 v5, v5, v28, v29
  v_max3_f32 v5, v5, v30, v31
  v_mfma_f32_16x16x32_bf16 v[92:95], a[140:143], v[8:11], 0
  v_add_f32_dpp v32, v81, v80 row_ror:12 row_mask:0xf bank_mask:0x1
  v_add_f32_dpp v32, v82, v32 row_ror:8 row_mask:0xf bank_mask:0x1
  v_add_f32_dpp v32, v83, v32 row_ror:4 row_mask:0xf bank_mask:0x1
  v_mfma_f32_16x16x32_bf16 v[80:83], a[144:147], v[8:11], 0
  v_add_f32_dpp v33, v85, v84 row_ror:12 row_mask:0xf bank_mask:0x1
  v_add_f32_dpp v33, v86, v33 row_ror:8 row_mask:0xf bank_mask:0x1
  v_add_f32_dpp v33, v87, v33 row_ror:4 row_mask:0xf bank_mask:0x1
  v_mfma_f32_16x16x32_bf16 v[84:87], a[148:151], v[8:11], 0
  v_add_f32_dpp v34, v89, v88 row_ror:12 row_mask:0xf bank_mask:0x1
  v_add_f32_dpp v34, v90, v34 row_ror:8 row_mask:0xf bank_mask:0x1
  v_add_f32_dpp v34, v91, v34 row_ror:4 row_mask:0xf bank_mask:0x1
  v_mfma_f32_16x16x32_bf16 v[88:91], a[152:155], v[8:11], 0
  v_add_f32_dpp v35, v93, v92 row_ror:12 row_mask:0xf bank_mask:0x1
  v_add_f32_dpp v35, v94, v35 row_ror:8 row_mask:0xf bank_mask:0x1
  v_add_f32_dpp v35, v95, v35 row_ror:4 row_mask:0xf bank_mask:0x1
  v_mfma_f32_16x16x32_bf16 v[92:95], a[156:159], v[8:11], 0
  v_add_f32_dpp v36, v81, v80 row_ror:12 row_mask:0xf bank_mask:0x1
  v_add_f32_dpp v36, v82, v36 row_ror:8 row_mask:0xf bank_mask:0x1
  v_add_f32_dpp v36, v83, v36 row_ror:4 row_mask:0xf bank_mask:0x1
  s_waitcnt vmcnt(8)
  s_add_u32 s73, s72, 10518528
  buffer_load_dwordx4 a[224:227], v3, s[32:35], s73 offen nt
  s_add_u32 s73, s72, 10522624
  buffer_load_dwordx4 a[228:231], v3, s[32:35], s73 offen nt
  s_add_u32 s73, s72, 10526720
  buffer_load_dwordx4 a[232:235], v3, s[32:35], s73 offen nt
  s_add_u32 s73, s72, 10530816
  buffer_load_dwordx4 a[236:239], v3, s[32:35], s73 offen nt
  s_add_u32 s73, s72, 10534912
  buffer_load_dwordx4 a[240:243], v3, s[32:35], s73 offen nt
  s_add_u32 s73, s72, 10539008
  buffer_load_dwordx4 a[244:247], v3, s[32:35], s73 offen nt
  s_add_u32 s73, s72, 10543104
  buffer_load_dwordx4 a[248:251], v3, s[32:35], s73 offen nt
  s_add_u32 s73, s72, 10547200
  buffer_load_dwordx4 a[252:255], v3, s[32:35], s73 offen nt
  v_mfma_f32_16x16x32_bf16 v[80:83], a[160:163], v[8:11], 0
  v_add_f32_dpp v37, v85, v84 row_ror:12 row_mask:0xf bank_mask:0x1
  v_add_f32_dpp v37, v86, v37 row_ror:8 row_mask:0xf bank_mask:0x1
  v_add_f32_dpp v37, v87, v37 row_ror:4 row_mask:0xf bank_mask:0x1
  v_mfma_f32_16x16x32_bf16 v[84:87], a[164:167], v[8:11], 0
  v_add_f32_dpp v38, v89, v88 row_ror:12 row_mask:0xf bank_mask:0x1
  v_add_f32_dpp v38, v90, v38 row_ror:8 row_mask:0xf bank_mask:0x1
  v_add_f32_dpp v38, v91, v38 row_ror:4 row_mask:0xf bank_mask:0x1
  v_mfma_f32_16x16x32_bf16 v[88:91], a[168:171], v[8:11], 0
  v_add_f32_dpp v39, v93, v92 row_ror:12 row_mask:0xf bank_mask:0x1
  v_add_f32_dpp v39, v94, v39 row_ror:8 row_mask:0xf bank_mask:0x1
  v_add_f32_dpp v39, v95, v39 row_ror:4 row_mask:0xf bank_mask:0x1
  v_mfma_f32_16x16x32_bf16 v[92:95], a[172:175], v[8:11], 0
  v_add_f32_dpp v32, v82, v81 row_ror:12 row_mask:0xf bank_mask:0x2
  v_add_f32_dpp v32, v83, v32 row_ror:8 row_mask:0xf bank_mask:0x2
  v_add_f32_dpp v32, v80, v32 row_ror:4 row_mask:0xf bank_mask:0x2
  v_mfma_f32_16x16x32_bf16 v[80:83], a[176:179], v[8:11], 0
  v_add_f32_dpp v33, v86, v85 row_ror:12 row_mask:0xf bank_mask:0x2
  v_add_f32_dpp v33, v87, v33 row_ror:8 row_mask:0xf bank_mask:0x2
  v_add_f32_dpp v33, v84, v33 row_ror:4 row_mask:0xf bank_mask:0x2
  v_mfma_f32_16x16x32_bf16 v[84:87], a[180:183], v[8:11], 0
  v_add_f32_dpp v34, v90, v89 row_ror:12 row_mask:0xf bank_mask:0x2
  v_add_f32_dpp v34, v91, v34 row_ror:8 row_mask:0xf bank_mask:0x2
  v_add_f32_dpp v34, v88, v34 row_ror:4 row_mask:0xf bank_mask:0x2
  v_mfma_f32_16x16x32_bf16 v[88:91], a[184:187], v[8:11], 0
  v_add_f32_dpp v35, v94, v93 row_ror:12 row_mask:0xf bank_mask:0x2
  v_add_f32_dpp v35, v95, v35 row_ror:8 row_mask:0xf bank_mask:0x2
  v_add_f32_dpp v35, v92, v35 row_ror:4 row_mask:0xf bank_mask:0x2
  v_mfma_f32_16x16x32_bf16 v[92:95], a[188:191], v[8:11], 0
  v_add_f32_dpp v36, v82, v81 row_ror:12 row_mask:0xf bank_mask:0x2
  v_add_f32_dpp v36, v83, v36 row_ror:8 row_mask:0xf bank_mask:0x2
  v_add_f32_dpp v36, v80, v36 row_ror:4 row_mask:0xf bank_mask:0x2
  s_waitcnt vmcnt(8)
  s_add_u32 s73, s72, 12582912
  buffer_load_dwordx4 a[0:3], v3, s[32:35], s73 offen nt
  s_add_u32 s73, s72, 12587008
  buffer_load_dwordx4 a[4:7], v3, s[32:35], s73 offen nt
  s_add_u32 s73, s72, 12591104
  buffer_load_dwordx4 a[8:11], v3, s[32:35], s73 offen nt
  s_add_u32 s73, s72, 12595200
  buffer_load_dwordx4 a[12:15], v3, s[32:35], s73 offen nt
  s_add_u32 s73, s72, 12599296
  buffer_load_dwordx4 a[16:19], v3, s[32:35], s73 offen nt
  s_add_u32 s73, s72, 12603392
  buffer_load_dwordx4 a[20:23], v3, s[32:35], s73 offen nt
  s_add_u32 s73, s72, 12607488
  buffer_load_dwordx4 a[24:27], v3, s[32:35], s73 offen nt
  s_add_u32 s73, s72, 12611584
  buffer_load_dwordx4 a[28:31], v3, s[32:35], s73 offen nt
  v_mfma_f32_16x16x32_bf16 v[80:83], a[192:195], v[8:11], 0
  v_add_f32_dpp v37, v86, v85 row_ror:12 row_mask:0xf bank_mask:0x2
  v_add_f32_dpp v37, v87, v37 row_ror:8 row_mask:0xf bank_mask:0x2
  v_add_f32_dpp v37, v84, v37 row_ror:4 row_mask:0xf bank_mask:0x2
  v_mfma_f32_16x16x32_bf16 v[84:87], a[196:199], v[8:11], 0
  v_add_f32_dpp v38, v90, v89 row_ror:12 row_mask:0xf bank_mask:0x2
  v_add_f32_dpp v38, v91, v38 row_ror:8 row_mask:0xf bank_mask:0x2
  v_add_f32_dpp v38, v88, v38 row_ror:4 row_mask:0xf bank_mask:0x2
  v_mfma_f32_16x16x32_bf16 v[88:91], a[200:203], v[8:11], 0
  v_add_f32_dpp v39, v94, v93 row_ror:12 row_mask:0xf bank_mask:0x2
  v_add_f32_dpp v39, v95, v39 row_ror:8 row_mask:0xf bank_mask:0x2
  v_add_f32_dpp v39, v92, v39 row_ror:4 row_mask:0xf bank_mask:0x2
  v_mfma_f32_16x16x32_bf16 v[92:95], a[204:207], v[8:11], 0
  v_add_f32_dpp v32, v83, v82 row_ror:12 row_mask:0xf bank_mask:0x4
  v_add_f32_dpp v32, v80, v32 row_ror:8 row_mask:0xf bank_mask:0x4
  v_add_f32_dpp v32, v81, v32 row_ror:4 row_mask:0xf bank_mask:0x4
  v_mfma_f32_16x16x32_bf16 v[80:83], a[208:211], v[8:11], 0
  v_add_f32_dpp v33, v87, v86 row_ror:12 row_mask:0xf bank_mask:0x4
  v_add_f32_dpp v33, v84, v33 row_ror:8 row_mask:0xf bank_mask:0x4
  v_add_f32_dpp v33, v85, v33 row_ror:4 row_mask:0xf bank_mask:0x4
  v_mfma_f32_16x16x32_bf16 v[84:87], a[212:215], v[8:11], 0
  v_add_f32_dpp v34, v91, v90 row_ror:12 row_mask:0xf bank_mask:0x4
  v_add_f32_dpp v34, v88, v34 row_ror:8 row_mask:0xf bank_mask:0x4
  v_add_f32_dpp v34, v89, v34 row_ror:4 row_mask:0xf bank_mask:0x4
  v_mfma_f32_16x16x32_bf16 v[88:91], a[216:219], v[8:11], 0
  v_add_f32_dpp v35, v95, v94 row_ror:12 row_mask:0xf bank_mask:0x4
  v_add_f32_dpp v35, v92, v35 row_ror:8 row_mask:0xf bank_mask:0x4
  v_add_f32_dpp v35, v93, v35 row_ror:4 row_mask:0xf bank_mask:0x4
  v_mfma_f32_16x16x32_bf16 v[92:95], a[220:223], v[8:11], 0
  v_add_f32_dpp v36, v83, v82 row_ror:12 row_mask:0xf bank_mask:0x4
  v_add_f32_dpp v36, v80, v36 row_ror:8 row_mask:0xf bank_mask:0x4
  v_add_f32_dpp v36, v81, v36 row_ror:4 row_mask:0xf bank_mask:0x4
  s_waitcnt vmcnt(8)
  s_add_u32 s73, s72, 12615680
  buffer_load_dwordx4 a[32:35], v3, s[32:35], s73 offen nt
  s_add_u32 s73, s72, 12619776
  buffer_load_dwordx4 a[36:39], v3, s[32:35], s73 offen nt
  s_add_u32 s73, s72, 12623872
  buffer_load_dwordx4 a[40:43], v3, s[32:35], s73 offen nt
  s_add_u32 s73, s72, 12627968
  buffer_load_dwordx4 a[44:47], v3, s[32:35], s73 offen nt
  s_add_u32 s73, s72, 12632064
  buffer_load_dwordx4 a[48:51], v3, s[32:35], s73 offen nt
  s_add_u32 s73, s72, 12636160
  buffer_load_dwordx4 a[52:55], v3, s[32:35], s73 offen nt
  s_add_u32 s73, s72, 12640256
  buffer_load_dwordx4 a[56:59], v3, s[32:35], s73 offen nt
  s_add_u32 s73, s72, 12644352
  buffer_load_dwordx4 a[60:63], v3, s[32:35], s73 offen nt
  v_mfma_f32_16x16x32_bf16 v[80:83], a[224:227], v[8:11], 0
  v_add_f32_dpp v37, v87, v86 row_ror:12 row_mask:0xf bank_mask:0x4
  v_add_f32_dpp v37, v84, v37 row_ror:8 row_mask:0xf bank_mask:0x4
  v_add_f32_dpp v37, v85, v37 row_ror:4 row_mask:0xf bank_mask:0x4
  v_mfma_f32_16x16x32_bf16 v[84:87], a[228:231], v[8:11], 0
  v_add_f32_dpp v38, v91, v90 row_ror:12 row_mask:0xf bank_mask:0x4
  v_add_f32_dpp v38, v88, v38 row_ror:8 row_mask:0xf bank_mask:0x4
  v_add_f32_dpp v38, v89, v38 row_ror:4 row_mask:0xf bank_mask:0x4
  v_mfma_f32_16x16x32_bf16 v[88:91], a[232:235], v[8:11], 0
  v_add_f32_dpp v39, v95, v94 row_ror:12 row_mask:0xf bank_mask:0x4
  v_add_f32_dpp v39, v92, v39 row_ror:8 row_mask:0xf bank_mask:0x4
  v_add_f32_dpp v39, v93, v39 row_ror:4 row_mask:0xf bank_mask:0x4
  v_mfma_f32_16x16x32_bf16 v[92:95], a[236:239], v[8:11], 0
  v_add_f32_dpp v32, v80, v83 row_ror:12 row_mask:0xf bank_mask:0x8
  v_add_f32_dpp v32, v81, v32 row_ror:8 row_mask:0xf bank_mask:0x8
  v_add_f32_dpp v32, v82, v32 row_ror:4 row_mask:0xf bank_mask:0x8
  v_mfma_f32_16x16x32_bf16 v[80:83], a[240:243], v[8:11], 0
  v_add_f32_dpp v33, v84, v87 row_ror:12 row_mask:0xf bank_mask:0x8
  v_add_f32_dpp v33, v85, v33 row_ror:8 row_mask:0xf bank_mask:0x8
  v_add_f32_dpp v33, v86, v33 row_ror:4 row_mask:0xf bank_mask:0x8
  v_mfma_f32_16x16x32_bf16 v[84:87], a[244:247], v[8:11], 0
  v_add_f32_dpp v34, v88, v91 row_ror:12 row_mask:0xf bank_mask:0x8
  v_add_f32_dpp v34, v89, v34 row_ror:8 row_mask:0xf bank_mask:0x8
  v_add_f32_dpp v34, v90, v34 row_ror:4 row_mask:0xf bank_mask:0x8
  v_mfma_f32_16x16x32_bf16 v[88:91], a[248:251], v[8:11], 0
  v_add_f32_dpp v35, v92, v95 row_ror:12 row_mask:0xf bank_mask:0x8
  v_add_f32_dpp v35, v93, v35 row_ror:8 row_mask:0xf bank_mask:0x8
  v_add_f32_dpp v35, v94, v35 row_ror:4 row_mask:0xf bank_mask:0x8
  v_mfma_f32_16x16x32_bf16 v[92:95], a[252:255], v[8:11], 0
  v_add_f32_dpp v36, v80, v83 row_ror:12 row_mask:0xf bank_mask:0x8
  v_add_f32_dpp v36, v81, v36 row_ror:8 row_mask:0xf bank_mask:0x8
  v_add_f32_dpp v36, v82, v36 row_ror:4 row_mask:0xf bank_mask:0x8
  s_waitcnt vmcnt(8)
  s_add_u32 s73, s72, 14680064
  buffer_load_dwordx4 a[64:67], v3, s[32:35], s73 offen nt
  s_add_u32 s73, s72, 14684160
  buffer_load_dwordx4 a[68:71], v3, s[32:35], s73 offen nt
  s_add_u32 s73, s72, 14688256
  buffer_load_dwordx4 a[72:75], v3, s[32:35], s73 offen nt
  s_add_u32 s73, s72, 14692352
  buffer_load_dwordx4 a[76:79], v3, s[32:35], s73 offen nt
  s_add_u32 s73, s72, 14696448
  buffer_load_dwordx4 a[80:83], v3, s[32:35], s73 offen nt
  s_add_u32 s73, s72, 14700544
  buffer_load_dwordx4 a[84:87], v3, s[32:35], s73 offen nt
  s_add_u32 s73, s72, 14704640
  buffer_load_dwordx4 a[88:91], v3, s[32:35], s73 offen nt
  s_add_u32 s73, s72, 14708736
  buffer_load_dwordx4 a[92:95], v3, s[32:35], s73 offen nt
  v_mfma_f32_16x16x32_bf16 v[80:83], a[0:3], v[8:11], 0
  v_add_f32_dpp v37, v84, v87 row_ror:12 row_mask:0xf bank_mask:0x8
  v_add_f32_dpp v37, v85, v37 row_ror:8 row_mask:0xf bank_mask:0x8
  v_add_f32_dpp v37, v86, v37 row_ror:4 row_mask:0xf bank_mask:0x8
  v_mfma_f32_16x16x32_bf16 v[84:87], a[4:7], v[8:11], 0
  v_add_f32_dpp v38, v88, v91 row_ror:12 row_mask:0xf bank_mask:0x8
  v_add_f32_dpp v38, v89, v38 row_ror:8 row_mask:0xf bank_mask:0x8
  v_add_f32_dpp v38, v90, v38 row_ror:4 row_mask:0xf bank_mask:0x8
  v_mfma_f32_16x16x32_bf16 v[88:91], a[8:11], v[8:11], 0
  v_add_f32_dpp v39, v92, v95 row_ror:12 row_mask:0xf bank_mask:0x8
  v_add_f32_dpp v39, v93, v39 row_ror:8 row_mask:0xf bank_mask:0x8
  v_add_f32_dpp v39, v94, v39 row_ror:4 row_mask:0xf bank_mask:0x8
  v_cvt_pk_bf16_f32 v32, 0, v32
  v_cvt_pk_bf16_f32 v33, 0, v33
  v_cvt_pk_bf16_f32 v34, 0, v34
  v_cvt_pk_bf16_f32 v35, 0, v35
  v_cvt_pk_bf16_f32 v36, 0, v36
  v_cvt_pk_bf16_f32 v37, 0, v37
  v_cvt_pk_bf16_f32 v38, 0, v38
  v_cvt_pk_bf16_f32 v39, 0, v39
  v_mul_f32 v32, 0x3db504f3, v32
  v_mul_f32 v33, 0x3db504f3, v33
  v_mul_f32 v34, 0x3db504f3, v34
  v_mul_f32 v35, 0x3db504f3, v35
  v_mul_f32 v36, 0x3db504f3, v36
  v_mul_f32 v37, 0x3db504f3, v37
  v_mul_f32 v38, 0x3db504f3, v38
  v_mul_f32 v39, 0x3db504f3, v39
  v_cvt_pk_bf16_f32 v32, 0, v32
  v_cvt_pk_bf16_f32 v33, 0, v33
  v_cvt_pk_bf16_f32 v34, 0, v34
  v_cvt_pk_bf16_f32 v35, 0, v35
  v_cvt_pk_bf16_f32 v36, 0, v36
  v_cvt_pk_bf16_f32 v37, 0, v37
  v_cvt_pk_bf16_f32 v38, 0, v38
  v_cvt_pk_bf16_f32 v39, 0, v39
  v_max3_f32 v5, v5, v32, v33
  v_max3_f32 v5, v5, v34, v35
  v_max3_f32 v5, v5, v36, v37
  v_max3_f32 v5, v5, v38, v39
  v_mfma_f32_16x16x32_bf16 v[92:95], a[12:15], v[8:11], 0
  v_add_f32_dpp v40, v81, v80 row_ror:12 row_mask:0xf bank_mask:0x1
  v_add_f32_dpp v40, v82, v40 row_ror:8 row_mask:0xf bank_mask:0x1
  v_add_f32_dpp v40, v83, v40 row_ror:4 row_mask:0xf bank_mask:0x1
  v_mfma_f32_16x16x32_bf16 v[80:83], a[16:19], v[8:11], 0
  v_add_f32_dpp v41, v85, v84 row_ror:12 row_mask:0xf bank_mask:0x1
  v_add_f32_dpp v41, v86, v41 row_ror:8 row_mask:0xf bank_mask:0x1
  v_add_f32_dpp v41, v87, v41 row_ror:4 row_mask:0xf bank_mask:0x1
  v_mfma_f32_16x16x32_bf16 v[84:87], a[20:23], v[8:11], 0
  v_add_f32_dpp v42, v89, v88 row_ror:12 row_mask:0xf bank_mask:0x1
  v_add_f32_dpp v42, v90, v42 row_ror:8 row_mask:0xf bank_mask:0x1
  v_add_f32_dpp v42, v91, v42 row_ror:4 row_mask:0xf bank_mask:0x1
  v_mfma_f32_16x16x32_bf16 v[88:91], a[24:27], v[8:11], 0
  v_add_f32_dpp v43, v93, v92 row_ror:12 row_mask:0xf bank_mask:0x1
  v_add_f32_dpp v43, v94, v43 row_ror:8 row_mask:0xf bank_mask:0x1
  v_add_f32_dpp v43, v95, v43 row_ror:4 row_mask:0xf bank_mask:0x1
  v_mfma_f32_16x16x32_bf16 v[92:95], a[28:31], v[8:11], 0
  v_add_f32_dpp v44, v81, v80 row_ror:12 row_mask:0xf bank_mask:0x1
  v_add_f32_dpp v44, v82, v44 row_ror:8 row_mask:0xf bank_mask:0x1
  v_add_f32_dpp v44, v83, v44 row_ror:4 row_mask:0xf bank_mask:0x1
  s_waitcnt vmcnt(8)
  s_add_u32 s73, s72, 14712832
  buffer_load_dwordx4 a[96:99], v3, s[32:35], s73 offen nt
  s_add_u32 s73, s72, 14716928
  buffer_load_dwordx4 a[100:103], v3, s[32:35], s73 offen nt
  s_add_u32 s73, s72, 14721024
  buffer_load_dwordx4 a[104:107], v3, s[32:35], s73 offen nt
  s_add_u32 s73, s72, 14725120
  buffer_load_dwordx4 a[108:111], v3, s[32:35], s73 offen nt
  s_add_u32 s73, s72, 14729216
  buffer_load_dwordx4 a[112:115], v3, s[32:35], s73 offen nt
  s_add_u32 s73, s72, 14733312
  buffer_load_dwordx4 a[116:119], v3, s[32:35], s73 offen nt
  s_add_u32 s73, s72, 14737408
  buffer_load_dwordx4 a[120:123], v3, s[32:35], s73 offen nt
  s_add_u32 s73, s72, 14741504
  buffer_load_dwordx4 a[124:127], v3, s[32:35], s73 offen nt
  v_bfe_u32 v12, v0, 3, 1
  v_lshlrev_b32 v12, 15, v12
  v_and_b32 v1, 7, v0
  v_lshl_add_u32 v12, v1, 10, v12
  v_lshrrev_b32 v1, 4, v0
  v_lshl_add_u32 v12, v1, 4, v12
  v_lshrrev_b32 v12, 5, v0
  v_lshlrev_b32 v12, 15, v12
  v_bfe_u32 v13, v0, 3, 1
  v_lshl_add_u32 v12, v13, 14, v12
  v_bfe_u32 v13, v0, 4, 1
  v_lshl_add_u32 v12, v13, 12, v12
  v_and_b32 v13, 7, v0
  v_lshl_add_u32 v12, v13, 4, v12
  v_lshrrev_b32 v13, 1, v0
  v_mul_u32_u24 v13, 14336, v13
  v_and_b32 v14, 1, v0
  v_lshl_add_u32 v13, v14, 4, v13
  v_lshlrev_b32 v14, 6, v1
  v_and_b32 v1, 3, v0
  v_lshl_add_u32 v14, v1, 4, v14
  v_bfe_u32 v1, v0, 2, 2
  v_lshl_add_u32 v14, v1, 12, v14
  s_lshl_b32 s6, s28, 19
  s_lshr_b32 s7, s29, 4
  s_lshl_b32 s7, s7, 18
  s_add_u32 s6, s6, s7
  s_lshl_b32 s7, s3, 16
  s_add_u32 s6, s6, s7
  s_lshl_b32 s7, s13, 7
  s_add_u32 s6, s6, s7
  s_or_b32 s82, s12, s3
  s_cmp_lg_u32 s82, 0
  s_cbranch_scc1 Lk_6
  s_memrealtime vcc
  v_mov_b32 v96, s31
  s_mul_i32 s81, s11, 600
  s_lshl_b32 s82, s25, 4
  s_add_u32 s82, s82, 26624
  s_waitcnt lgkmcnt(0)
  s_add_u32 s81, s81, vcc_lo
  v_mov_b32 v97, s81
  s_sub_u32 s81, vcc_lo, s14
  v_mov_b32 v98, s81
  s_mov_b64 exec, 1
  buffer_store_dwordx3 v[96:98], v2, s[40:43], s82 offen sc1
  s_mov_b64 exec, -1
Lk_6:
  v_mfma_f32_16x16x32_bf16 v[80:83], a[32:35], v[8:11], 0
  v_add_f32_dpp v45, v85, v84 row_ror:12 row_mask:0xf bank_mask:0x1
  v_add_f32_dpp v45, v86, v45 row_ror:8 row_mask:0xf bank_mask:0x1
  v_add_f32_dpp v45, v87, v45 row_ror:4 row_mask:0xf bank_mask:0x1
  v_mfma_f32_16x16x32_bf16 v[84:87], a[36:39], v[8:11], 0
  v_add_f32_dpp v46, v89, v88 row_ror:12 row_mask:0xf bank_mask:0x1
  v_add_f32_dpp v46, v90, v46 row_ror:8 row_mask:0xf bank_mask:0x1
  v_add_f32_dpp v46, v91, v46 row_ror:4 row_mask:0xf bank_mask:0x1
  v_mfma_f32_16x16x32_bf16 v[88:91], a[40:43], v[8:11], 0
  v_add_f32_dpp v47, v93, v92 row_ror:12 row_mask:0xf bank_mask:0x1
  v_add_f32_dpp v47, v94, v47 row_ror:8 row_mask:0xf bank_mask:0x1
  v_add_f32_dpp v47, v95, v47 row_ror:4 row_mask:0xf bank_mask:0x1
  v_mfma_f32_16x16x32_bf16 v[92:95], a[44:47], v[8:11], 0
  v_add_f32_dpp v40, v82, v81 row_ror:12 row_mask:0xf bank_mask:0x2
  v_add_f32_dpp v40, v83, v40 row_ror:8 row_mask:0xf bank_mask:0x2
  v_add_f32_dpp v40, v80, v40 row_ror:4 row_mask:0xf bank_mask:0x2
  v_mfma_f32_16x16x32_bf16 v[80:83], a[48:51], v[8:11], 0
  v_add_f32_dpp v41, v86, v85 row_ror:12 row_mask:0xf bank_mask:0x2
  v_add_f32_dpp v41, v87, v41 row_ror:8 row_mask:0xf bank_mask:0x2
  v_add_f32_dpp v41, v84, v41 row_ror:4 row_mask:0xf bank_mask:0x2
  v_mfma_f32_16x16x32_bf16 v[84:87], a[52:55], v[8:11], 0
  v_add_f32_dpp v42, v90, v89 row_ror:12 row_mask:0xf bank_mask:0x2
  v_add_f32_dpp v42, v91, v42 row_ror:8 row_mask:0xf bank_mask:0x2
  v_add_f32_dpp v42, v88, v42 row_ror:4 row_mask:0xf bank_mask:0x2
  v_mfma_f32_16x16x32_bf16 v[88:91], a[56:59], v[8:11], 0
  v_add_f32_dpp v43, v94, v93 row_ror:12 row_mask:0xf bank_mask:0x2
  v_add_f32_dpp v43, v95, v43 row_ror:8 row_mask:0xf bank_mask:0x2
  v_add_f32_dpp v43, v92, v43 row_ror:4 row_mask:0xf bank_mask:0x2
  v_mfma_f32_16x16x32_bf16 v[92:95], a[60:63], v[8:11], 0
  v_add_f32_dpp v44, v82, v81 row_ror:12 row_mask:0xf bank_mask:0x2
  v_add_f32_dpp v44, v83, v44 row_ror:8 row_mask:0xf bank_mask:0x2
  v_add_f32_dpp v44, v80, v44 row_ror:4 row_mask:0xf bank_mask:0x2
  s_waitcnt vmcnt(8)
  s_add_u32 s73, s72, 0
  buffer_load_dwordx4 v[128:131], v2, s[36:39], s73 offen nt
  s_add_u32 s73, s72, 4096
  buffer_load_dwordx4 v[132:135], v2, s[36:39], s73 offen nt
  s_add_u32 s73, s72, 8192
  buffer_load_dwordx4 v[136:139], v2, s[36:39], s73 offen nt
  s_add_u32 s73, s72, 12288
  buffer_load_dwordx4 v[140:143], v2, s[36:39], s73 offen nt
  s_add_u32 s73, s72, 16384
  buffer_load_dwordx4 v[144:147], v2, s[36:39], s73 offen nt
  s_add_u32 s73, s72, 20480
  buffer_load_dwordx4 v[148:151], v2, s[36:39], s73 offen nt
  s_add_u32 s73, s72, 24576
  buffer_load_dwordx4 v[152:155], v2, s[36:39], s73 offen nt
  s_add_u32 s73, s72, 28672
  buffer_load_dwordx4 v[156:159], v2, s[36:39], s73 offen nt
  v_mfma_f32_16x16x32_bf16 v[80:83], a[64:67], v[8:11], 0
  v_add_f32_dpp v45, v86, v85 row_ror:12 row_mask:0xf bank_mask:0x2
  v_add_f32_dpp v45, v87, v45 row_ror:8 row_mask:0xf bank_mask:0x2
  v_add_f32_dpp v45, v84, v45 row_ror:4 row_mask:0xf bank_mask:0x2
  v_mfma_f32_16x16x32_bf16 v[84:87], a[68:71], v[8:11], 0
  v_add_f32_dpp v46, v90, v89 row_ror:12 row_mask:0xf bank_mask:0x2
  v_add_f32_dpp v46, v91, v46 row_ror:8 row_mask:0xf bank_mask:0x2
  v_add_f32_dpp v46, v88, v46 row_ror:4 row_mask:0xf bank_mask:0x2
  v_mfma_f32_16x16x32_bf16 v[88:91], a[72:75], v[8:11], 0
  v_add_f32_dpp v47, v94, v93 row_ror:12 row_mask:0xf bank_mask:0x2
  v_add_f32_dpp v47, v95, v47 row_ror:8 row_mask:0xf bank_mask:0x2
  v_add_f32_dpp v47, v92, v47 row_ror:4 row_mask:0xf bank_mask:0x2
  v_mfma_f32_16x16x32_bf16 v[92:95], a[76:79], v[8:11], 0
  v_add_f32_dpp v40, v83, v82 row_ror:12 row_mask:0xf bank_mask:0x4
  v_add_f32_dpp v40, v80, v40 row_ror:8 row_mask:0xf bank_mask:0x4
  v_add_f32_dpp v40, v81, v40 row_ror:4 row_mask:0xf bank_mask:0x4
  v_mfma_f32_16x16x32_bf16 v[80:83], a[80:83], v[8:11], 0
  v_add_f32_dpp v41, v87, v86 row_ror:12 row_mask:0xf bank_mask:0x4
  v_add_f32_dpp v41, v84, v41 row_ror:8 row_mask:0xf bank_mask:0x4
  v_add_f32_dpp v41, v85, v41 row_ror:4 row_mask:0xf bank_mask:0x4
  v_mfma_f32_16x16x32_bf16 v[84:87], a[84:87], v[8:11], 0
  v_add_f32_dpp v42, v91, v90 row_ror:12 row_mask:0xf bank_mask:0x4
  v_add_f32_dpp v42, v88, v42 row_ror:8 row_mask:0xf bank_mask:0x4
  v_add_f32_dpp v42, v89, v42 row_ror:4 row_mask:0xf bank_mask:0x4
  v_mfma_f32_16x16x32_bf16 v[88:91], a[88:91], v[8:11], 0
  v_add_f32_dpp v43, v95, v94 row_ror:12 row_mask:0xf bank_mask:0x4
  v_add_f32_dpp v43, v92, v43 row_ror:8 row_mask:0xf bank_mask:0x4
  v_add_f32_dpp v43, v93, v43 row_ror:4 row_mask:0xf bank_mask:0x4
  v_mfma_f32_16x16x32_bf16 v[92:95], a[92:95], v[8:11], 0
  v_add_f32_dpp v44, v83, v82 row_ror:12 row_mask:0xf bank_mask:0x4
  v_add_f32_dpp v44, v80, v44 row_ror:8 row_mask:0xf bank_mask:0x4
  v_add_f32_dpp v44, v81, v44 row_ror:4 row_mask:0xf bank_mask:0x4
  s_waitcnt vmcnt(8)
  s_add_u32 s73, s72, 32768
  buffer_load_dwordx4 v[160:163], v2, s[36:39], s73 offen nt
  s_add_u32 s73, s72, 36864
  buffer_load_dwordx4 v[164:167], v2, s[36:39], s73 offen nt
  s_add_u32 s73, s72, 40960
  buffer_load_dwordx4 v[168:171], v2, s[36:39], s73 offen nt
  s_add_u32 s73, s72, 45056
  buffer_load_dwordx4 v[172:175], v2, s[36:39], s73 offen nt
  s_add_u32 s73, s72, 49152
  buffer_load_dwordx4 v[176:179], v2, s[36:39], s73 offen nt
  s_add_u32 s73, s72, 53248
  buffer_load_dwordx4 v[180:183], v2, s[36:39], s73 offen nt
  s_add_u32 s73, s72, 57344
  buffer_load_dwordx4 v[184:187], v2, s[36:39], s73 offen nt
  s_add_u32 s73, s72, 61440
  buffer_load_dwordx4 v[188:191], v2, s[36:39], s73 offen nt
  v_mfma_f32_16x16x32_bf16 v[80:83], a[96:99], v[8:11], 0
  v_add_f32_dpp v45, v87, v86 row_ror:12 row_mask:0xf bank_mask:0x4
  v_add_f32_dpp v45, v84, v45 row_ror:8 row_mask:0xf bank_mask:0x4
  v_add_f32_dpp v45, v85, v45 row_ror:4 row_mask:0xf bank_mask:0x4
  v_mfma_f32_16x16x32_bf16 v[84:87], a[100:103], v[8:11], 0
  v_add_f32_dpp v46, v91, v90 row_ror:12 row_mask:0xf bank_mask:0x4
  v_add_f32_dpp v46, v88, v46 row_ror:8 row_mask:0xf bank_mask:0x4
  v_add_f32_dpp v46, v89, v46 row_ror:4 row_mask:0xf bank_mask:0x4
  v_mfma_f32_16x16x32_bf16 v[88:91], a[104:107], v[8:11], 0
  v_add_f32_dpp v47, v95, v94 row_ror:12 row_mask:0xf bank_mask:0x4
  v_add_f32_dpp v47, v92, v47 row_ror:8 row_mask:0xf bank_mask:0x4
  v_add_f32_dpp v47, v93, v47 row_ror:4 row_mask:0xf bank_mask:0x4
  v_mfma_f32_16x16x32_bf16 v[92:95], a[108:111], v[8:11], 0
  v_add_f32_dpp v40, v80, v83 row_ror:12 row_mask:0xf bank_mask:0x8
  v_add_f32_dpp v40, v81, v40 row_ror:8 row_mask:0xf bank_mask:0x8
  v_add_f32_dpp v40, v82, v40 row_ror:4 row_mask:0xf bank_mask:0x8
  v_mfma_f32_16x16x32_bf16 v[80:83], a[112:115], v[8:11], 0
  v_add_f32_dpp v41, v84, v87 row_ror:12 row_mask:0xf bank_mask:0x8
  v_add_f32_dpp v41, v85, v41 row_ror:8 row_mask:0xf bank_mask:0x8
  v_add_f32_dpp v41, v86, v41 row_ror:4 row_mask:0xf bank_mask:0x8
  v_mfma_f32_16x16x32_bf16 v[84:87], a[116:119], v[8:11], 0
  v_add_f32_dpp v42, v88, v91 row_ror:12 row_mask:0xf bank_mask:0x8
  v_add_f32_dpp v42, v89, v42 row_ror:8 row_mask:0xf bank_mask:0x8
  v_add_f32_dpp v42, v90, v42 row_ror:4 row_mask:0xf bank_mask:0x8
  v_mfma_f32_16x16x32_bf16 v[88:91], a[120:123], v[8:11], 0
  v_add_f32_dpp v43, v92, v95 row_ror:12 row_mask:0xf bank_mask:0x8
  v_add_f32_dpp v43, v93, v43 row_ror:8 row_mask:0xf bank_mask:0x8
  v_add_f32_dpp v43, v94, v43 row_ror:4 row_mask:0xf bank_mask:0x8
  v_mfma_f32_16x16x32_bf16 v[92:95], a[124:127], v[8:11], 0
  v_add_f32_dpp v44, v80, v83 row_ror:12 row_mask:0xf bank_mask:0x8
  v_add_f32_dpp v44, v81, v44 row_ror:8 row_mask:0xf bank_mask:0x8
  v_add_f32_dpp v44, v82, v44 row_ror:4 row_mask:0xf bank_mask:0x8
  v_add_f32_dpp v45, v84, v87 row_ror:12 row_mask:0xf bank_mask:0x8
  v_add_f32_dpp v45, v85, v45 row_ror:8 row_mask:0xf bank_mask:0x8
  v_add_f32_dpp v45, v86, v45 row_ror:4 row_mask:0xf bank_mask:0x8
  v_add_f32_dpp v46, v88, v91 row_ror:12 row_mask:0xf bank_mask:0x8
  v_add_f32_dpp v46, v89, v46 row_ror:8 row_mask:0xf bank_mask:0x8
  v_add_f32_dpp v46, v90, v46 row_ror:4 row_mask:0xf bank_mask:0x8
  v_add_f32_dpp v47, v92, v95 row_ror:12 row_mask:0xf bank_mask:0x8
  v_add_f32_dpp v47, v93, v47 row_ror:8 row_mask:0xf bank_mask:0x8
  v_add_f32_dpp v47, v94, v47 row_ror:4 row_mask:0xf bank_mask:0x8
  v_cvt_pk_bf16_f32 v40, 0, v40
  v_cvt_pk_bf16_f32 v41, 0, v41
  v_cvt_pk_bf16_f32 v42, 0, v42
  v_cvt_pk_bf16_f32 v43, 0, v43
  v_cvt_pk_bf16_f32 v44, 0, v44
  v_cvt_pk_bf16_f32 v45, 0, v45
  v_cvt_pk_bf16_f32 v46, 0, v46
  v_cvt_pk_bf16_f32 v47, 0, v47
  v_mul_f32 v40, 0x3db504f3, v40
  v_mul_f32 v41, 0x3db504f3, v41
  v_mul_f32 v42, 0x3db504f3, v42
  v_mul_f32 v43, 0x3db504f3, v43
  v_mul_f32 v44, 0x3db504f3, v44
  v_mul_f32 v45, 0x3db504f3, v45
  v_mul_f32 v46, 0x3db504f3, v46
  v_mul_f32 v47, 0x3db504f3, v47
  v_cvt_pk_bf16_f32 v40, 0, v40
  v_cvt_pk_bf16_f32 v41, 0, v41
  v_cvt_pk_bf16_f32 v42, 0, v42
  v_cvt_pk_bf16_f32 v43, 0, v43
  v_cvt_pk_bf16_f32 v44, 0, v44
  v_cvt_pk_bf16_f32 v45, 0, v45
  v_cvt_pk_bf16_f32 v46, 0, v46
  v_cvt_pk_bf16_f32 v47, 0, v47
  v_max3_f32 v5, v5, v40, v41
  v_max3_f32 v5, v5, v42, v43
  v_max3_f32 v5, v5, v44, v45
  v_max3_f32 v5, v5, v46, v47
  v_sub_f32 v16, v16, v5
  v_sub_f32 v17, v17, v5
  v_sub_f32 v18, v18, v5
  v_sub_f32 v19, v19, v5
  v_sub_f32 v20, v20, v5
  v_sub_f32 v21, v21, v5
  v_sub_f32 v22, v22, v5
  v_sub_f32 v23, v23, v5
  v_sub_f32 v24, v24, v5
  v_sub_f32 v25, v25, v5
  v_sub_f32 v26, v26, v5
  v_sub_f32 v27, v27, v5
  v_sub_f32 v28, v28, v5
  v_sub_f32 v29, v29, v5
  v_sub_f32 v30, v30, v5
  v_sub_f32 v31, v31, v5
  v_sub_f32 v32, v32, v5
  v_sub_f32 v33, v33, v5
  v_sub_f32 v34, v34, v5
  v_sub_f32 v35, v35, v5
  v_sub_f32 v36, v36, v5
  v_sub_f32 v37, v37, v5
  v_sub_f32 v38, v38, v5
  v_sub_f32 v39, v39, v5
  v_sub_f32 v40, v40, v5
  v_sub_f32 v41, v41, v5
  v_sub_f32 v42, v42, v5
  v_sub_f32 v43, v43, v5
  v_sub_f32 v44, v44, v5
  v_sub_f32 v45, v45, v5
  v_sub_f32 v46, v46, v5
  v_sub_f32 v47, v47, v5
  v_mul_f32 v16, 0x3fb8aa3b, v16
  v_mul_f32 v17, 0x3fb8aa3b, v17
  v_mul_f32 v18, 0x3fb8aa3b, v18
  v_mul_f32 v19, 0x3fb8aa3b, v19
  v_mul_f32 v20, 0x3fb8aa3b, v20
  v_mul_f32 v21, 0x3fb8aa3b, v21
  v_mul_f32 v22, 0x3fb8aa3b, v22
  v_mul_f32 v23, 0x3fb8aa3b, v23
  v_mul_f32 v24, 0x3fb8aa3b, v24
  v_mul_f32 v25, 0x3fb8aa3b, v25
  v_mul_f32 v26, 0x3fb8aa3b, v26
  v_mul_f32 v27, 0x3fb8aa3b, v27
  v_mul_f32 v28, 0x3fb8aa3b, v28
  v_mul_f32 v29, 0x3fb8aa3b, v29
  v_mul_f32 v30, 0x3fb8aa3b, v30
  v_mul_f32 v31, 0x3fb8aa3b, v31
  v_mul_f32 v32, 0x3fb8aa3b, v32
  v_mul_f32 v33, 0x3fb8aa3b, v33
  v_mul_f32 v34, 0x3fb8aa3b, v34
  v_mul_f32 v35, 0x3fb8aa3b, v35
  v_mul_f32 v36, 0x3fb8aa3b, v36
  v_mul_f32 v37, 0x3fb8aa3b, v37
  v_mul_f32 v38, 0x3fb8aa3b, v38
  v_mul_f32 v39, 0x3fb8aa3b, v39
  v_mul_f32 v40, 0x3fb8aa3b, v40
  v_mul_f32 v41, 0x3fb8aa3b, v41
  v_mul_f32 v42, 0x3fb8aa3b, v42
  v_mul_f32 v43, 0x3fb8aa3b, v43
  v_mul_f32 v44, 0x3fb8aa3b, v44
  v_mul_f32 v45, 0x3fb8aa3b, v45
  v_mul_f32 v46, 0x3fb8aa3b, v46
  v_mul_f32 v47, 0x3fb8aa3b, v47
  v_exp_f32 v16, v16
  v_exp_f32 v17, v17
  v_exp_f32 v18, v18
  v_exp_f32 v19, v19
  v_exp_f32 v20, v20
  v_exp_f32 v21, v21
  v_exp_f32 v22, v22
  v_exp_f32 v23, v23
  v_exp_f32 v24, v24
  v_exp_f32 v25, v25
  v_exp_f32 v26, v26
  v_exp_f32 v27, v27
  v_exp_f32 v28, v28
  v_exp_f32 v29, v29
  v_exp_f32 v30, v30
  v_exp_f32 v31, v31
  v_exp_f32 v32, v32
  v_exp_f32 v33, v33
  v_exp_f32 v34, v34
  v_exp_f32 v35, v35
  v_exp_f32 v36, v36
  v_exp_f32 v37, v37
  v_exp_f32 v38, v38
  v_exp_f32 v39, v39
  v_exp_f32 v40, v40
  v_exp_f32 v41, v41
  v_exp_f32 v42, v42
  v_exp_f32 v43, v43
  v_exp_f32 v44, v44
  v_exp_f32 v45, v45
  v_exp_f32 v46, v46
  v_exp_f32 v47, v47
  v_add_f32 v80, v16, v20
  v_add_f32 v81, v17, v21
  v_add_f32 v82, v18, v22
  v_add_f32 v83, v19, v23
  v_add_f32 v80, v80, v24
  v_add_f32 v81, v81, v25
  v_add_f32 v82, v82, v26
  v_add_f32 v83, v83, v27
  v_add_f32 v80, v80, v28
  v_add_f32 v81, v81, v29
  v_add_f32 v82, v82, v30
  v_add_f32 v83, v83, v31
  v_add_f32 v80, v80, v32
  v_add_f32 v81, v81, v33
  v_add_f32 v82, v82, v34
  v_add_f32 v83, v83, v35
  v_add_f32 v80, v80, v36
  v_add_f32 v81, v81, v37
  v_add_f32 v82, v82, v38
  v_add_f32 v83, v83, v39
  v_add_f32 v80, v80, v40
  v_add_f32 v81, v81, v41
  v_add_f32 v82, v82, v42
  v_add_f32 v83, v83, v43
  v_add_f32 v80, v80, v44
  v_add_f32 v81, v81, v45
  v_add_f32 v82, v82, v46
  v_add_f32 v83, v83, v47
  v_add_f32 v80, v80, v81
  v_add_f32 v82, v82, v83
  v_add_f32 v6, v80, v82
  v_mov_b32 v84, v5
  s_nop 1
  v_max_f32_dpp v84, v84, v84 row_ror:4 row_mask:0xf bank_mask:0xf
  s_nop 1
  v_max_f32_dpp v84, v84, v84 row_ror:8 row_mask:0xf bank_mask:0xf
  v_mov_b32 v86, v84
  s_nop 1
  v_permlane16_swap_b32 v84, v86
  s_nop 0
  v_max_f32 v84, v84, v86
  v_mov_b32 v86, v84
  s_nop 1
  v_permlane32_swap_b32 v84, v86
  s_nop 0
  v_max_f32 v84, v84, v86
  v_sub_f32 v85, v5, v84
  v_mul_f32 v85, 0x3fb8aa3b, v85
  v_exp_f32 v85, v85
  s_nop 0
  v_mul_f32 v85, v85, v6
  s_nop 1
  v_add_f32_dpp v85, v85, v85 row_ror:4 row_mask:0xf bank_mask:0xf
  s_nop 1
  v_add_f32_dpp v85, v85, v85 row_ror:8 row_mask:0xf bank_mask:0xf
  v_mov_b32 v86, v85
  s_nop 1
  v_permlane16_swap_b32 v85, v86
  s_nop 0
  v_add_f32 v85, v85, v86
  v_mov_b32 v86, v85
  s_nop 1
  v_permlane32_swap_b32 v85, v86
  s_nop 0
  v_add_f32 v85, v85, v86
  v_lshlrev_b32 v87, 3, v0
  s_lshl_b32 s81, s3, 5
  v_add_u32 v86, s81, v87
  v_mov_b32 v88, 0
  v_mov_b32 v89, 1
  s_mov_b64 exec, 0xf
  ds_write_b64 v86, v[84:85] offset:512
  s_mov_b64 exec, 1
  ds_add_rtn_u32 v90, v88, v89 offset:256
  s_mov_b64 exec, -1
  v_and_b32 v87, 0x78, v87
  s_waitcnt lgkmcnt(0)
  v_readfirstlane_b32 s81, v90
  s_nop 0
  s_cmp_lg_u32 s81, 3
  s_cbranch_scc1 Ls_7
  ds_read_b64 v[88:89], v87 offset:512
  s_memrealtime vcc
  s_lshl_b32 s81, s28, 11
  s_lshl_b32 s82, s29, 6
  s_add_u32 s81, s81, s82
  s_add_u32 s81, s81, 32768
  s_lshl_b32 s82, s2, 2
  s_add_u32 s82, s82, 24576
  s_waitcnt lgkmcnt(0)
  v_mov_b32 v92, v88
  s_nop 1
  v_max_f32_dpp v92, v92, v92 row_ror:4 row_mask:0xf bank_mask:0xf
  s_nop 1
  v_max_f32_dpp v92, v92, v92 row_ror:8 row_mask:0xf bank_mask:0xf
  v_sub_f32 v86, v88, v92
  v_mul_f32 v86, 0x3fb8aa3b, v86
  v_exp_f32 v86, v86
  s_nop 0
  v_mul_f32 v89, v89, v86
  s_nop 1
  v_add_f32_dpp v89, v89, v89 row_ror:4 row_mask:0xf bank_mask:0xf
  s_nop 1
  v_add_f32_dpp v89, v89, v89 row_ror:8 row_mask:0xf bank_mask:0xf
  v_or_b32 v92, s76, v92
  v_and_b32 v93, 0xffff0000, v89
  v_or_b32 v93, s76, v93
  v_lshlrev_b32 v94, 16, v89
  v_or_b32 v94, s76, v94
  v_mov_b32 v95, s15
  v_mov_b32 v86, s31
  s_mov_b64 exec, 0xf
  buffer_store_dwordx4 v[92:95], v2, s[40:43], s81 offen sc1
  s_mov_b64 exec, 1
  buffer_store_dword v86, v2, s[40:43], s82 offen sc1
  s_mov_b64 exec, -1
Ls_7:
  s_waitcnt vmcnt(8)
  s_add_u32 s73, s72, 2097152
  buffer_load_dwordx4 v[192:195], v2, s[36:39], s73 offen nt
  s_add_u32 s73, s72, 2101248
  buffer_load_dwordx4 v[196:199], v2, s[36:39], s73 offen nt
  s_add_u32 s73, s72, 2105344
  buffer_load_dwordx4 v[200:203], v2, s[36:39], s73 offen nt
  s_add_u32 s73, s72, 2109440
  buffer_load_dwordx4 v[204:207], v2, s[36:39], s73 offen nt
  s_add_u32 s73, s72, 2113536
  buffer_load_dwordx4 v[208:211], v2, s[36:39], s73 offen nt
  s_add_u32 s73, s72, 2117632
  buffer_load_dwordx4 v[212:215], v2, s[36:39], s73 offen nt
  s_add_u32 s73, s72, 2121728
  buffer_load_dwordx4 v[216:219], v2, s[36:39], s73 offen nt
  s_add_u32 s73, s72, 2125824
  buffer_load_dwordx4 v[220:223], v2, s[36:39], s73 offen nt
  s_waitcnt vmcnt(8)
  s_add_u32 s73, s72, 2129920
  buffer_load_dwordx4 v[224:227], v2, s[36:39], s73 offen nt
  s_add_u32 s73, s72, 2134016
  buffer_load_dwordx4 v[228:231], v2, s[36:39], s73 offen nt
  s_add_u32 s73, s72, 2138112
  buffer_load_dwordx4 v[232:235], v2, s[36:39], s73 offen nt
  s_add_u32 s73, s72, 2142208
  buffer_load_dwordx4 v[236:239], v2, s[36:39], s73 offen nt
  s_add_u32 s73, s72, 2146304
  buffer_load_dwordx4 v[240:243], v2, s[36:39], s73 offen nt
  s_add_u32 s73, s72, 2150400
  buffer_load_dwordx4 v[244:247], v2, s[36:39], s73 offen nt
  s_add_u32 s73, s72, 2154496
  buffer_load_dwordx4 v[248:251], v2, s[36:39], s73 offen nt
  s_add_u32 s73, s72, 2158592
  buffer_load_dwordx4 v[252:255], v2, s[36:39], s73 offen nt
  v_lshlrev_b32 v15, 4, v0
  v_add_u32 v15, 26624, v15
  buffer_load_dwordx3 v[100:102], v15, s[40:43], 0 offen sc1
  s_waitcnt vmcnt(9)
  s_barrier
  s_add_u32 s73, s72, 4194304
  buffer_load_dwordx4 a[128:131], v2, s[36:39], s73 offen nt
  s_add_u32 s73, s72, 4198400
  buffer_load_dwordx4 a[132:135], v2, s[36:39], s73 offen nt
  s_add_u32 s73, s72, 4202496
  buffer_load_dwordx4 a[136:139], v2, s[36:39], s73 offen nt
  s_add_u32 s73, s72, 4206592
  buffer_load_dwordx4 a[140:143], v2, s[36:39], s73 offen nt
  s_add_u32 s73, s72, 4210688
  buffer_load_dwordx4 a[144:147], v2, s[36:39], s73 offen nt
  s_add_u32 s73, s72, 4214784
  buffer_load_dwordx4 a[148:151], v2, s[36:39], s73 offen nt
  s_add_u32 s73, s72, 4218880
  buffer_load_dwordx4 a[152:155], v2, s[36:39], s73 offen nt
  s_add_u32 s73, s72, 4222976
  buffer_load_dwordx4 a[156:159], v2, s[36:39], s73 offen nt
  s_waitcnt vmcnt(9)
  s_add_u32 s73, s72, 4227072
  buffer_load_dwordx4 a[160:163], v2, s[36:39], s73 offen nt
  s_add_u32 s73, s72, 4231168
  buffer_load_dwordx4 a[164:167], v2, s[36:39], s73 offen nt
  s_add_u32 s73, s72, 4235264
  buffer_load_dwordx4 a[168:171], v2, s[36:39], s73 offen nt
  s_add_u32 s73, s72, 4239360
  buffer_load_dwordx4 a[172:175], v2, s[36:39], s73 offen nt
  s_add_u32 s73, s72, 4243456
  buffer_load_dwordx4 a[176:179], v2, s[36:39], s73 offen nt
  s_add_u32 s73, s72, 4247552
  buffer_load_dwordx4 a[180:183], v2, s[36:39], s73 offen nt
  s_add_u32 s73, s72, 4251648
  buffer_load_dwordx4 a[184:187], v2, s[36:39], s73 offen nt
  s_add_u32 s73, s72, 4255744
  buffer_load_dwordx4 a[188:191], v2, s[36:39], s73 offen nt
  s_waitcnt vmcnt(16)
  v_cmp_ne_u32 s[86:87], s31, v100
  s_nop 0
  s_mov_b64 s[84:85], s[86:87]
  s_cmp_eq_u64 s[84:85], 0
  s_cbranch_scc1 Lpd_8
  s_mov_b32 s78, 200000
Lpr_9:
  s_cmp_eq_u64 s[86:87], 0
  s_cbranch_scc1 Lps_10
  s_mov_b64 exec, s[86:87]
  buffer_load_dwordx3 v[100:102], v15, s[40:43], 0 offen sc1
Lps_10:
  s_mov_b64 exec, -1
  s_waitcnt vmcnt(0)
  s_cmp_eq_u64 s[86:87], 0
  s_cbranch_scc1 Lpc_11
  v_cmp_ne_u32 s[86:87], s31, v100
Lpc_11:
  s_nop 0
  s_mov_b64 s[84:85], s[86:87]
  s_cmp_eq_u64 s[84:85], 0
  s_cbranch_scc1 Lpd_8
  s_sub_u32 s78, s78, 1
  s_cmp_lg_u32 s78, 0
  s_cbranch_scc1 Lpr_9
Lpd_8:
  v_readfirstlane_b32 s81, v101
  s_memrealtime vcc
  s_nop 0
  v_subrev_u32 v98, s81, v101
  s_nop 1
  v_add_u32_dpp v98, v98, v98 row_ror:8 row_mask:0xf bank_mask:0xf
  v_add_u32_dpp v102, v102, v102 row_ror:8 row_mask:0xf bank_mask:0xf
  s_nop 0
  v_add_u32_dpp v98, v98, v98 row_ror:4 row_mask:0xf bank_mask:0xf
  v_add_u32_dpp v102, v102, v102 row_ror:4 row_mask:0xf bank_mask:0xf
  s_nop 0
  v_add_u32_dpp v98, v98, v98 row_ror:2 row_mask:0xf bank_mask:0xf
  v_add_u32_dpp v102, v102, v102 row_ror:2 row_mask:0xf bank_mask:0xf
  s_nop 0
  v_add_u32_dpp v98, v98, v98 row_ror:1 row_mask:0xf bank_mask:0xf
  v_add_u32_dpp v102, v102, v102 row_ror:1 row_mask:0xf bank_mask:0xf
  s_nop 0
  v_add_u32_dpp v98, v98, v98 row_bcast:15 row_mask:0xa bank_mask:0xf
  v_add_u32_dpp v102, v102, v102 row_bcast:15 row_mask:0xa bank_mask:0xf
  s_nop 0
  v_add_u32_dpp v98, v98, v98 row_bcast:31 row_mask:0xc bank_mask:0xf
  v_add_u32_dpp v102, v102, v102 row_bcast:31 row_mask:0xc bank_mask:0xf
  s_nop 0
  v_readlane_b32 s16, v102, 63
  s_nop 0
  s_min_u32 s16, s16, 0x40000
  s_mul_i32 s16, s16, 69
  s_lshr_b32 s16, s16, 16
  v_readlane_b32 s14, v98, 63
  s_nop 0
  s_ashr_i32 s14, s14, 6
  s_add_u32 s14, s14, s81
  s_waitcnt lgkmcnt(0)
  s_sub_u32 s14, s14, vcc_lo
  s_min_i32 s14, s14, 0
  s_max_i32 s14, s14, -0x100000
  s_add_u32 s14, s14, vcc_lo
  s_mul_i32 vcc_lo, s16, 5
  s_add_u32 s14, s14, vcc_lo
  s_sub_u32 s81, 0x2000000, s81
  v_add_u32 v101, s81, v101
  v_lshl_add_u32 v101, v101, 6, v0
  s_nop 0
  v_readlane_b32 s81, v101, s25
  s_nop 1
  v_cmp_gt_u32 vcc, s81, v101
  s_nop 0
  s_bcnt1_i32_b64 s5, vcc
  s_lshl_b32 s5, s5, 2
  s_add_u32 s4, s4, s5
  s_cmp_lt_u32 s4, 112
  s_cselect_b32 s5, 1, 0
  s_cselect_b32 s58, 1835008, 0
  s_cselect_b32 s62, 1835008, 0
  s_cselect_b32 s66, 1835008, 0
  s_mul_i32 s7, s3, 458752
  s_lshl_b32 s8, s4, 5
  s_add_u32 s7, s7, s8
  s_lshl_b32 s8, s4, 14
  s_lshl_b32 s81, s3, 8
  s_add_u32 s8, s8, s81
  s_waitcnt vmcnt(8)
  s_add_u32 s14, s14, s16
  s_cmp_lg_u32 s5, 0
  s_cbranch_scc1 Lw_13
Lw_12:
  s_memrealtime vcc
  s_waitcnt lgkmcnt(0)
  s_sub_u32 vcc_lo, vcc_lo, s14
  s_cmp_ge_i32 vcc_lo, -290
  s_cbranch_scc1 Lw_13
  s_sleep 2
  s_branch Lw_12
Lw_13:
  s_barrier
  s_add_u32 s73, s72, 6291456
  buffer_load_dwordx4 a[192:195], v2, s[36:39], s73 offen nt
  s_add_u32 s73, s72, 6295552
  buffer_load_dwordx4 a[196:199], v2, s[36:39], s73 offen nt
  s_add_u32 s73, s72, 6299648
  buffer_load_dwordx4 a[200:203], v2, s[36:39], s73 offen nt
  s_add_u32 s73, s72, 6303744
  buffer_load_dwordx4 a[204:207], v2, s[36:39], s73 offen nt
  s_add_u32 s73, s72, 6307840
  buffer_load_dwordx4 a[208:211], v2, s[36:39], s73 offen nt
  s_add_u32 s73, s72, 6311936
  buffer_load_dwordx4 a[212:215], v2, s[36:39], s73 offen nt
  s_add_u32 s73, s72, 6316032
  buffer_load_dwordx4 a[216:219], v2, s[36:39], s73 offen nt
  s_add_u32 s73, s72, 6320128
  buffer_load_dwordx4 a[220:223], v2, s[36:39], s73 offen nt
  s_lshl_b32 s83, s28, 11
  s_add_u32 s83, s83, 32768
  buffer_load_dwordx4 v[48:51], v2, s[40:43], s83 offen sc1
  buffer_load_dwordx4 v[52:55], v2, s[40:43], s83 offen offset:1024 sc1
  s_waitcnt vmcnt(10)
  s_add_u32 s14, s14, s16
  s_cmp_lg_u32 s5, 0
  s_cbranch_scc1 Lw_15
Lw_14:
  s_memrealtime vcc
  s_waitcnt lgkmcnt(0)
  s_sub_u32 vcc_lo, vcc_lo, s14
  s_cmp_ge_i32 vcc_lo, -290
  s_cbranch_scc1 Lw_15
  s_sleep 2
  s_branch Lw_14
Lw_15:
  s_add_u32 s73, s72, 6324224
  buffer_load_dwordx4 a[224:227], v2, s[36:39], s73 offen nt
  s_add_u32 s73, s72, 6328320
  buffer_load_dwordx4 a[228:231], v2, s[36:39], s73 offen nt
  s_add_u32 s73, s72, 6332416
  buffer_load_dwordx4 a[232:235], v2, s[36:39], s73 offen nt
  s_add_u32 s73, s72, 6336512
  buffer_load_dwordx4 a[236:239], v2, s[36:39], s73 offen nt
  s_add_u32 s73, s72, 6340608
  buffer_load_dwordx4 a[240:243], v2, s[36:39], s73 offen nt
  s_add_u32 s73, s72, 6344704
  buffer_load_dwordx4 a[244:247], v2, s[36:39], s73 offen nt
  s_add_u32 s73, s72, 6348800
  buffer_load_dwordx4 a[248:251], v2, s[36:39], s73 offen nt
  s_add_u32 s73, s72, 6352896
  buffer_load_dwordx4 a[252:255], v2, s[36:39], s73 offen nt
  s_waitcnt vmcnt(10)
  s_add_u32 s14, s14, s16
  s_cmp_lg_u32 s5, 0
  s_cbranch_scc1 Lw_17
Lw_16:
  s_memrealtime vcc
  s_waitcnt lgkmcnt(0)
  s_sub_u32 vcc_lo, vcc_lo, s14
  s_cmp_ge_i32 vcc_lo, -290
  s_cbranch_scc1 Lw_17
  s_sleep 2
  s_branch Lw_16
Lw_17:
  s_barrier
  s_add_u32 s73, s72, 8388608
  buffer_load_dwordx4 a[0:3], v2, s[36:39], s73 offen nt
  s_add_u32 s73, s72, 8392704
  buffer_load_dwordx4 a[4:7], v2, s[36:39], s73 offen nt
  s_add_u32 s73, s72, 8396800
  buffer_load_dwordx4 a[8:11], v2, s[36:39], s73 offen nt
  s_add_u32 s73, s72, 8400896
  buffer_load_dwordx4 a[12:15], v2, s[36:39], s73 offen nt
  s_add_u32 s73, s72, 8404992
  buffer_load_dwordx4 a[16:19], v2, s[36:39], s73 offen nt
  s_add_u32 s73, s72, 8409088
  buffer_load_dwordx4 a[20:23], v2, s[36:39], s73 offen nt
  s_add_u32 s73, s72, 8413184
  buffer_load_dwordx4 a[24:27], v2, s[36:39], s73 offen nt
  s_add_u32 s73, s72, 8417280
  buffer_load_dwordx4 a[28:31], v2, s[36:39], s73 offen nt
  s_waitcnt vmcnt(16)
  v_perm_b32 v56, v49, v48, s74
  v_perm_b32 v57, v53, v52, s74
  v_perm_b32 v58, v54, v50, s74
  v_perm_b32 v59, v55, v51, s74
  v_xor_b32 v56, s77, v56
  v_xor_b32 v57, s77, v57
  v_xor_b32 v58, s77, v58
  v_xor_b32 v59, s77, v59
  v_or3_b32 v56, v56, v57, v58
  v_or_b32 v56, v56, v59
  v_cmp_ne_u32 s[86:87], 0, v56
  s_nop 0
  s_mov_b64 s[84:85], s[86:87]
  s_cmp_eq_u64 s[84:85], 0
  s_cbranch_scc1 Lpd_18
  s_mov_b32 s78, 200000
Lpr_19:
  s_cmp_eq_u64 s[86:87], 0
  s_cbranch_scc1 Lps_20
  s_mov_b64 exec, s[86:87]
  buffer_load_dwordx4 v[48:51], v2, s[40:43], s83 offen sc1
  buffer_load_dwordx4 v[52:55], v2, s[40:43], s83 offen offset:1024 sc1
Lps_20:
  s_mov_b64 exec, -1
  s_waitcnt vmcnt(0)
  s_cmp_eq_u64 s[86:87], 0
  s_cbranch_scc1 Lpc_21
  v_perm_b32 v56, v49, v48, s74
  v_perm_b32 v57, v53, v52, s74
  v_perm_b32 v58, v54, v50, s74
  v_perm_b32 v59, v55, v51, s74
  v_xor_b32 v56, s77, v56
  v_xor_b32 v57, s77, v57
  v_xor_b32 v58, s77, v58
  v_xor_b32 v59, s77, v59
  v_or3_b32 v56, v56, v57, v58
  v_or_b32 v56, v56, v59
  v_cmp_ne_u32 s[86:87], 0, v56
Lpc_21:
  s_nop 0
  s_mov_b64 s[84:85], s[86:87]
  s_cmp_eq_u64 s[84:85], 0
  s_cbranch_scc1 Lpd_18
  s_sub_u32 s78, s78, 1
  s_cmp_lg_u32 s78, 0
  s_cbranch_scc1 Lpr_19
Lpd_18:
  v_xor_b32 v56, s15, v51
  v_xor_b32 v57, s15, v55
  v_or_b32 v56, v56, v57
  v_cmp_ne_u32 vcc, 0, v56
  s_nop 0
  s_cmp_eq_u64 vcc, 0
  s_cselect_b32 s27, 1, 0
  v_and_b32 v56, 0xffff0000, v48
  v_and_b32 v57, 0xffff0000, v52
  v_perm_b32 v58, v49, v50, s75
  v_perm_b32 v59, v53, v54, s75
  v_max_f32 v60, v56, v57
  s_nop 1
  v_max_f32_dpp v60, v60, v60 row_ror:4 row_mask:0xf bank_mask:0xf
  s_nop 1
  v_max_f32_dpp v60, v60, v60 row_ror:8 row_mask:0xf bank_mask:0xf
  v_mov_b32 v61, v60
  s_nop 1
  v_permlane16_swap_b32 v60, v61
  s_nop 0
  v_max_f32 v60, v60, v61
  v_mov_b32 v61, v60
  s_nop 1
  v_permlane32_swap_b32 v60, v61
  s_nop 0
  v_max_f32 v60, v60, v61
  v_sub_f32 v56, v56, v60
  v_mul_f32 v56, 0x3fb8aa3b, v56
  v_exp_f32 v56, v56
  v_sub_f32 v57, v57, v60
  v_mul_f32 v57, 0x3fb8aa3b, v57
  v_exp_f32 v57, v57
  v_mul_f32 v58, v58, v56
  v_fmac_f32 v58, v59, v57
  s_nop 1
  v_add_f32_dpp v58, v58, v58 row_ror:4 row_mask:0xf bank_mask:0xf
  s_nop 1
  v_add_f32_dpp v58, v58, v58 row_ror:8 row_mask:0xf bank_mask:0xf
  v_mov_b32 v61, v58
  s_nop 1
  v_permlane16_swap_b32 v58, v61
  s_nop 0
  v_add_f32 v58, v58, v61
  v_mov_b32 v61, v58
  s_nop 1
  v_permlane32_swap_b32 v58, v61
  s_nop 0
  v_add_f32 v58, v58, v61
  v_rcp_f32 v59, v58
  v_sub_f32 v62, v5, v60
  v_mul_f32 v62, 0x3fb8aa3b, v62
  v_exp_f32 v62, v62
  v_fma_f32 v61, -v58, v59, 1.0
  v_fmac_f32 v59, v61, v59
  v_mul_f32 v62, v62, v59
  v_mul_f32 v16, v16, v62
  v_mul_f32 v17, v17, v62
  v_mul_f32 v18, v18, v62
  v_mul_f32 v19, v19, v62
  v_mul_f32 v20, v20, v62
  v_mul_f32 v21, v21, v62
  v_mul_f32 v22, v22, v62
  v_mul_f32 v23, v23, v62
  v_mul_f32 v24, v24, v62
  v_mul_f32 v25, v25, v62
  v_mul_f32 v26, v26, v62
  v_mul_f32 v27, v27, v62
  v_mul_f32 v28, v28, v62
  v_mul_f32 v29, v29, v62
  v_mul_f32 v30, v30, v62
  v_mul_f32 v31, v31, v62
  v_mul_f32 v32, v32, v62
  v_mul_f32 v33, v33, v62
  v_mul_f32 v34, v34, v62
  v_mul_f32 v35, v35, v62
  v_mul_f32 v36, v36, v62
  v_mul_f32 v37, v37, v62
  v_mul_f32 v38, v38, v62
  v_mul_f32 v39, v39, v62
  v_mul_f32 v40, v40, v62
  v_mul_f32 v41, v41, v62
  v_mul_f32 v42, v42, v62
  v_mul_f32 v43, v43, v62
  v_mul_f32 v44, v44, v62
  v_mul_f32 v45, v45, v62
  v_mul_f32 v46, v46, v62
  v_mul_f32 v47, v47, v62
  v_cvt_pk_bf16_f32 v16, v16, v17
  v_cvt_pk_bf16_f32 v17, v18, v19
  v_cvt_pk_bf16_f32 v18, v20, v21
  v_cvt_pk_bf16_f32 v19, v22, v23
  v_cvt_pk_bf16_f32 v24, v24, v25
  v_cvt_pk_bf16_f32 v25, v26, v27
  v_cvt_pk_bf16_f32 v26, v28, v29
  v_cvt_pk_bf16_f32 v27, v30, v31
  v_cvt_pk_bf16_f32 v32, v32, v33
  v_cvt_pk_bf16_f32 v33, v34, v35
  v_cvt_pk_bf16_f32 v34, v36, v37
  v_cvt_pk_bf16_f32 v35, v38, v39
  v_cvt_pk_bf16_f32 v40, v40, v41
  v_cvt_pk_bf16_f32 v41, v42, v43
  v_cvt_pk_bf16_f32 v42, v44, v45
  v_cvt_pk_bf16_f32 v43, v46, v47
  v_perm_b32 v80, v132, v128, s74
  v_perm_b32 v81, v140, v136, s74
  v_perm_b32 v82, v148, v144, s74
  v_perm_b32 v83, v156, v152, s74
  v_perm_b32 v84, v132, v128, s75
  v_perm_b32 v85, v140, v136, s75
  v_perm_b32 v86, v148, v144, s75
  v_perm_b32 v87, v156, v152, s75
  v_mfma_f32_16x16x32_bf16 v[48:51], v[80:83], v[16:19], 0
  s_nop 0
  v_mfma_f32_16x16x32_bf16 v[52:55], v[84:87], v[16:19], 0
  v_perm_b32 v88, v133, v129, s74
  v_perm_b32 v89, v141, v137, s74
  v_perm_b32 v90, v149, v145, s74
  v_perm_b32 v91, v157, v153, s74
  v_perm_b32 v92, v133, v129, s75
  v_perm_b32 v93, v141, v137, s75
  v_perm_b32 v94, v149, v145, s75
  v_perm_b32 v95, v157, v153, s75
  v_mfma_f32_16x16x32_bf16 v[56:59], v[88:91], v[16:19], 0
  s_nop 0
  v_mfma_f32_16x16x32_bf16 v[60:63], v[92:95], v[16:19], 0
  v_perm_b32 v80, v134, v130, s74
  v_perm_b32 v81, v142, v138, s74
  v_perm_b32 v82, v150, v146, s74
  v_perm_b32 v83, v158, v154, s74
  v_perm_b32 v84, v134, v130, s75
  v_perm_b32 v85, v142, v138, s75
  v_perm_b32 v86, v150, v146, s75
  v_perm_b32 v87, v158, v154, s75
  v_mfma_f32_16x16x32_bf16 v[64:67], v[80:83], v[16:19], 0
  s_nop 0
  v_mfma_f32_16x16x32_bf16 v[68:71], v[84:87], v[16:19], 0
  v_perm_b32 v88, v135, v131, s74
  v_perm_b32 v89, v143, v139, s74
  v_perm_b32 v90, v151, v147, s74
  v_perm_b32 v91, v159, v155, s74
  v_perm_b32 v92, v135, v131, s75
  v_perm_b32 v93, v143, v139, s75
  v_perm_b32 v94, v151, v147, s75
  v_perm_b32 v95, v159, v155, s75
  v_mfma_f32_16x16x32_bf16 v[72:75], v[88:91], v[16:19], 0
  s_nop 0
  v_mfma_f32_16x16x32_bf16 v[76:79], v[92:95], v[16:19], 0
  v_mov_b32_dpp v116, v16 row_ror:12 row_mask:0xf bank_mask:0xf
  v_mov_b32_dpp v117, v17 row_ror:12 row_mask:0xf bank_mask:0xf
  v_mov_b32_dpp v118, v18 row_ror:12 row_mask:0xf bank_mask:0xf
  v_mov_b32_dpp v119, v19 row_ror:12 row_mask:0xf bank_mask:0xf
  v_perm_b32 v80, v164, v160, s74
  v_perm_b32 v81, v172, v168, s74
  v_perm_b32 v82, v180, v176, s74
  v_perm_b32 v83, v188, v184, s74
  v_perm_b32 v84, v164, v160, s75
  v_perm_b32 v85, v172, v168, s75
  v_perm_b32 v86, v180, v176, s75
  v_perm_b32 v87, v188, v184, s75
  v_mfma_f32_16x16x32_bf16 v[48:51], v[80:83], v[116:119], v[48:51]
  s_nop 0
  v_mfma_f32_16x16x32_bf16 v[52:55], v[84:87], v[116:119], v[52:55]
  v_perm_b32 v88, v165, v161, s74
  v_perm_b32 v89, v173, v169, s74
  v_perm_b32 v90, v181, v177, s74
  v_perm_b32 v91, v189, v185, s74
  v_perm_b32 v92, v165, v161, s75
  v_perm_b32 v93, v173, v169, s75
  v_perm_b32 v94, v181, v177, s75
  v_perm_b32 v95, v189, v185, s75
  v_mfma_f32_16x16x32_bf16 v[56:59], v[88:91], v[116:119], v[56:59]
  s_nop 0
  v_mfma_f32_16x16x32_bf16 v[60:63], v[92:95], v[116:119], v[60:63]
  v_perm_b32 v80, v166, v162, s74
  v_perm_b32 v81, v174, v170, s74
  v_perm_b32 v82, v182, v178, s74
  v_perm_b32 v83, v190, v186, s74
  v_perm_b32 v84, v166, v162, s75
  v_perm_b32 v85, v174, v170, s75
  v_perm_b32 v86, v182, v178, s75
  v_perm_b32 v87, v190, v186, s75
  v_mfma_f32_16x16x32_bf16 v[64:67], v[80:83], v[116:119], v[64:67]
  s_nop 0
  v_mfma_f32_16x16x32_bf16 v[68:71], v[84:87], v[116:119], v[68:71]
  v_perm_b32 v88, v167, v163, s74
  v_perm_b32 v89, v175, v171, s74
  v_perm_b32 v90, v183, v179, s74
  v_perm_b32 v91, v191, v187, s74
  v_perm_b32 v92, v167, v163, s75
  v_perm_b32 v93, v175, v171, s75
  v_perm_b32 v94, v183, v179, s75
  v_perm_b32 v95, v191, v187, s75
  v_mfma_f32_16x16x32_bf16 v[72:75], v[88:91], v[116:119], v[72:75]
  s_nop 0
  v_mfma_f32_16x16x32_bf16 v[76:79], v[92:95], v[116:119], v[76:79]
  v_mov_b32_dpp v112, v16 row_ror:8 row_mask:0xf bank_mask:0xf
  v_mov_b32_dpp v113, v17 row_ror:8 row_mask:0xf bank_mask:0xf
  v_mov_b32_dpp v114, v18 row_ror:8 row_mask:0xf bank_mask:0xf
  v_mov_b32_dpp v115, v19 row_ror:8 row_mask:0xf bank_mask:0xf
  v_perm_b32 v80, v196, v192, s74
  v_perm_b32 v81, v204, v200, s74
  v_perm_b32 v82, v212, v208, s74
  v_perm_b32 v83, v220, v216, s74
  v_perm_b32 v84, v196, v192, s75
  v_perm_b32 v85, v204, v200, s75
  v_perm_b32 v86, v212, v208, s75
  v_perm_b32 v87, v220, v216, s75
  v_mfma_f32_16x16x32_bf16 v[48:51], v[80:83], v[112:115], v[48:51]
  s_nop 0
  v_mfma_f32_16x16x32_bf16 v[52:55], v[84:87], v[112:115], v[52:55]
  v_perm_b32 v88, v197, v193, s74
  v_perm_b32 v89, v205, v201, s74
  v_perm_b32 v90, v213, v209, s74
  v_perm_b32 v91, v221, v217, s74
  v_perm_b32 v92, v197, v193, s75
  v_perm_b32 v93, v205, v201, s75
  v_perm_b32 v94, v213, v209, s75
  v_perm_b32 v95, v221, v217, s75
  v_mfma_f32_16x16x32_bf16 v[56:59], v[88:91], v[112:115], v[56:59]
  s_nop 0
  v_mfma_f32_16x16x32_bf16 v[60:63], v[92:95], v[112:115], v[60:63]
  v_perm_b32 v80, v198, v194, s74
  v_perm_b32 v81, v206, v202, s74
  v_perm_b32 v82, v214, v210, s74
  v_perm_b32 v83, v222, v218, s74
  v_perm_b32 v84, v198, v194, s75
  v_perm_b32 v85, v206, v202, s75
  v_perm_b32 v86, v214, v210, s75
  v_perm_b32 v87, v222, v218, s75
  v_mfma_f32_16x16x32_bf16 v[64:67], v[80:83], v[112:115], v[64:67]
  s_nop 0
  v_mfma_f32_16x16x32_bf16 v[68:71], v[84:87], v[112:115], v[68:71]
  v_perm_b32 v88, v199, v195, s74
  v_perm_b32 v89, v207, v203, s74
  v_perm_b32 v90, v215, v211, s74
  v_perm_b32 v91, v223, v219, s74
  v_perm_b32 v92, v199, v195, s75
  v_perm_b32 v93, v207, v203, s75
  v_perm_b32 v94, v215, v211, s75
  v_perm_b32 v95, v223, v219, s75
  v_mfma_f32_16x16x32_bf16 v[72:75], v[88:91], v[112:115], v[72:75]
  s_nop 0
  v_mfma_f32_16x16x32_bf16 v[76:79], v[92:95], v[112:115], v[76:79]
  s_waitcnt vmcnt(8)
  s_add_u32 s14, s14, s16
  s_cmp_lg_u32 s5, 0
  s_cbranch_scc1 Lw_23
Lw_22:
  s_memrealtime vcc
  s_waitcnt lgkmcnt(0)
  s_sub_u32 vcc_lo, vcc_lo, s14
  s_cmp_ge_i32 vcc_lo, -290
  s_cbranch_scc1 Lw_23
  s_sleep 2
  s_branch Lw_22
Lw_23:
  s_add_u32 s73, s72, 8421376
  buffer_load_dwordx4 a[32:35], v2, s[36:39], s73 offen nt
  s_add_u32 s73, s72, 8425472
  buffer_load_dwordx4 a[36:39], v2, s[36:39], s73 offen nt
  s_add_u32 s73, s72, 8429568
  buffer_load_dwordx4 a[40:43], v2, s[36:39], s73 offen nt
  s_add_u32 s73, s72, 8433664
  buffer_load_dwordx4 a[44:47], v2, s[36:39], s73 offen nt
  s_add_u32 s73, s72, 8437760
  buffer_load_dwordx4 a[48:51], v2, s[36:39], s73 offen nt
  s_add_u32 s73, s72, 8441856
  buffer_load_dwordx4 a[52:55], v2, s[36:39], s73 offen nt
  s_add_u32 s73, s72, 8445952
  buffer_load_dwordx4 a[56:59], v2, s[36:39], s73 offen nt
  s_add_u32 s73, s72, 8450048
  buffer_load_dwordx4 a[60:63], v2, s[36:39], s73 offen nt
  s_mov_b32 s9, 24576
  buffer_load_dwordx4 v[124:127], v2, s[40:43], s9 offen sc1
  v_mov_b32_dpp v116, v16 row_ror:4 row_mask:0xf bank_mask:0xf
  v_mov_b32_dpp v117, v17 row_ror:4 row_mask:0xf bank_mask:0xf
  v_mov_b32_dpp v118, v18 row_ror:4 row_mask:0xf bank_mask:0xf
  v_mov_b32_dpp v119, v19 row_ror:4 row_mask:0xf bank_mask:0xf
  v_perm_b32 v80, v228, v224, s74
  v_perm_b32 v81, v236, v232, s74
  v_perm_b32 v82, v244, v240, s74
  v_perm_b32 v83, v252, v248, s74
  v_perm_b32 v84, v228, v224, s75
  v_perm_b32 v85, v236, v232, s75
  v_perm_b32 v86, v244, v240, s75
  v_perm_b32 v87, v252, v248, s75
  v_mfma_f32_16x16x32_bf16 v[48:51], v[80:83], v[116:119], v[48:51]
  s_nop 0
  v_mfma_f32_16x16x32_bf16 v[52:55], v[84:87], v[116:119], v[52:55]
  v_perm_b32 v88, v229, v225, s74
  v_perm_b32 v89, v237, v233, s74
  v_perm_b32 v90, v245, v241, s74
  v_perm_b32 v91, v253, v249, s74
  v_perm_b32 v92, v229, v225, s75
  v_perm_b32 v93, v237, v233, s75
  v_perm_b32 v94, v245, v241, s75
  v_perm_b32 v95, v253, v249, s75
  v_mfma_f32_16x16x32_bf16 v[56:59], v[88:91], v[116:119], v[56:59]
  s_nop 0
  v_mfma_f32_16x16x32_bf16 v[60:63], v[92:95], v[116:119], v[60:63]
  v_perm_b32 v80, v230, v226, s74
  v_perm_b32 v81, v238, v234, s74
  v_perm_b32 v82, v246, v242, s74
  v_perm_b32 v83, v254, v250, s74
  v_perm_b32 v84, v230, v226, s75
  v_perm_b32 v85, v238, v234, s75
  v_perm_b32 v86, v246, v242, s75
  v_perm_b32 v87, v254, v250, s75
  v_mfma_f32_16x16x32_bf16 v[64:67], v[80:83], v[116:119], v[64:67]
  s_nop 0
  v_mfma_f32_16x16x32_bf16 v[68:71], v[84:87], v[116:119], v[68:71]
  v_perm_b32 v88, v231, v227, s74
  v_perm_b32 v89, v239, v235, s74
  v_perm_b32 v90, v247, v243, s74
  v_perm_b32 v91, v255, v251, s74
  v_perm_b32 v92, v231, v227, s75
  v_perm_b32 v93, v239, v235, s75
  v_perm_b32 v94, v247, v243, s75
  v_perm_b32 v95, v255, v251, s75
  v_mfma_f32_16x16x32_bf16 v[72:75], v[88:91], v[116:119], v[72:75]
  s_nop 0
  v_mfma_f32_16x16x32_bf16 v[76:79], v[92:95], v[116:119], v[76:79]
  v_accvgpr_read_b32 v96, a128
  v_accvgpr_read_b32 v97, a132
  v_accvgpr_read_b32 v98, a136
  v_accvgpr_read_b32 v99, a140
  v_accvgpr_read_b32 v100, a144
  v_accvgpr_read_b32 v101, a148
  v_accvgpr_read_b32 v102, a152
  v_accvgpr_read_b32 v103, a156
  v_perm_b32 v80, v97, v96, s74
  v_perm_b32 v81, v99, v98, s74
  v_perm_b32 v82, v101, v100, s74
  v_perm_b32 v83, v103, v102, s74
  v_perm_b32 v84, v97, v96, s75
  v_perm_b32 v85, v99, v98, s75
  v_perm_b32 v86, v101, v100, s75
  v_perm_b32 v87, v103, v102, s75
  v_mfma_f32_16x16x32_bf16 v[48:51], v[80:83], v[24:27], v[48:51]
  s_nop 0
  v_mfma_f32_16x16x32_bf16 v[52:55], v[84:87], v[24:27], v[52:55]
  v_accvgpr_read_b32 v104, a129
  v_accvgpr_read_b32 v105, a133
  v_accvgpr_read_b32 v106, a137
  v_accvgpr_read_b32 v107, a141
  v_accvgpr_read_b32 v108, a145
  v_accvgpr_read_b32 v109, a149
  v_accvgpr_read_b32 v110, a153
  v_accvgpr_read_b32 v111, a157
  v_perm_b32 v88, v105, v104, s74
  v_perm_b32 v89, v107, v106, s74
  v_perm_b32 v90, v109, v108, s74
  v_perm_b32 v91, v111, v110, s74
  v_perm_b32 v92, v105, v104, s75
  v_perm_b32 v93, v107, v106, s75
  v_perm_b32 v94, v109, v108, s75
  v_perm_b32 v95, v111, v110, s75
  v_mfma_f32_16x16x32_bf16 v[56:59], v[88:91], v[24:27], v[56:59]
  s_nop 0
  v_mfma_f32_16x16x32_bf16 v[60:63], v[92:95], v[24:27], v[60:63]
  v_accvgpr_read_b32 v96, a130
  v_accvgpr_read_b32 v97, a134
  v_accvgpr_read_b32 v98, a138
  v_accvgpr_read_b32 v99, a142
  v_accvgpr_read_b32 v100, a146
  v_accvgpr_read_b32 v101, a150
  v_accvgpr_read_b32 v102, a154
  v_accvgpr_read_b32 v103, a158
  v_perm_b32 v80, v97, v96, s74
  v_perm_b32 v81, v99, v98, s74
  v_perm_b32 v82, v101, v100, s74
  v_perm_b32 v83, v103, v102, s74
  v_perm_b32 v84, v97, v96, s75
  v_perm_b32 v85, v99, v98, s75
  v_perm_b32 v86, v101, v100, s75
  v_perm_b32 v87, v103, v102, s75
  v_mfma_f32_16x16x32_bf16 v[64:67], v[80:83], v[24:27], v[64:67]
  s_nop 0
  v_mfma_f32_16x16x32_bf16 v[68:71], v[84:87], v[24:27], v[68:71]
  v_accvgpr_read_b32 v104, a131
  v_accvgpr_read_b32 v105, a135
  v_accvgpr_read_b32 v106, a139
  v_accvgpr_read_b32 v107, a143
  v_accvgpr_read_b32 v108, a147
  v_accvgpr_read_b32 v109, a151
  v_accvgpr_read_b32 v110, a155
  v_accvgpr_read_b32 v111, a159
  v_perm_b32 v88, v105, v104, s74
  v_perm_b32 v89, v107, v106, s74
  v_perm_b32 v90, v109, v108, s74
  v_perm_b32 v91, v111, v110, s74
  v_perm_b32 v92, v105, v104, s75
  v_perm_b32 v93, v107, v106, s75
  v_perm_b32 v94, v109, v108, s75
  v_perm_b32 v95, v111, v110, s75
  v_mfma_f32_16x16x32_bf16 v[72:75], v[88:91], v[24:27], v[72:75]
  s_nop 0
  v_mfma_f32_16x16x32_bf16 v[76:79], v[92:95], v[24:27], v[76:79]
  v_mov_b32_dpp v116, v24 row_ror:12 row_mask:0xf bank_mask:0xf
  v_mov_b32_dpp v117, v25 row_ror:12 row_mask:0xf bank_mask:0xf
  v_mov_b32_dpp v118, v26 row_ror:12 row_mask:0xf bank_mask:0xf
  v_mov_b32_dpp v119, v27 row_ror:12 row_mask:0xf bank_mask:0xf
  v_accvgpr_read_b32 v96, a160
  v_accvgpr_read_b32 v97, a164
  v_accvgpr_read_b32 v98, a168
  v_accvgpr_read_b32 v99, a172
  v_accvgpr_read_b32 v100, a176
  v_accvgpr_read_b32 v101, a180
  v_accvgpr_read_b32 v102, a184
  v_accvgpr_read_b32 v103, a188
  v_perm_b32 v80, v97, v96, s74
  v_perm_b32 v81, v99, v98, s74
  v_perm_b32 v82, v101, v100, s74
  v_perm_b32 v83, v103, v102, s74
  v_perm_b32 v84, v97, v96, s75
  v_perm_b32 v85, v99, v98, s75
  v_perm_b32 v86, v101, v100, s75
  v_perm_b32 v87, v103, v102, s75
  v_mfma_f32_16x16x32_bf16 v[48:51], v[80:83], v[116:119], v[48:51]
  s_nop 0
  v_mfma_f32_16x16x32_bf16 v[52:55], v[84:87], v[116:119], v[52:55]
  v_accvgpr_read_b32 v104, a161
  v_accvgpr_read_b32 v105, a165
  v_accvgpr_read_b32 v106, a169
  v_accvgpr_read_b32 v107, a173
  v_accvgpr_read_b32 v108, a177
  v_accvgpr_read_b32 v109, a181
  v_accvgpr_read_b32 v110, a185
  v_accvgpr_read_b32 v111, a189
  v_perm_b32 v88, v105, v104, s74
  v_perm_b32 v89, v107, v106, s74
  v_perm_b32 v90, v109, v108, s74
  v_perm_b32 v91, v111, v110, s74
  v_perm_b32 v92, v105, v104, s75
  v_perm_b32 v93, v107, v106, s75
  v_perm_b32 v94, v109, v108, s75
  v_perm_b32 v95, v111, v110, s75
  v_mfma_f32_16x16x32_bf16 v[56:59], v[88:91], v[116:119], v[56:59]
  s_nop 0
  v_mfma_f32_16x16x32_bf16 v[60:63], v[92:95], v[116:119], v[60:63]
  v_accvgpr_read_b32 v96, a162
  v_accvgpr_read_b32 v97, a166
  v_accvgpr_read_b32 v98, a170
  v_accvgpr_read_b32 v99, a174
  v_accvgpr_read_b32 v100, a178
  v_accvgpr_read_b32 v101, a182
  v_accvgpr_read_b32 v102, a186
  v_accvgpr_read_b32 v103, a190
  v_perm_b32 v80, v97, v96, s74
  v_perm_b32 v81, v99, v98, s74
  v_perm_b32 v82, v101, v100, s74
  v_perm_b32 v83, v103, v102, s74
  v_perm_b32 v84, v97, v96, s75
  v_perm_b32 v85, v99, v98, s75
  v_perm_b32 v86, v101, v100, s75
  v_perm_b32 v87, v103, v102, s75
  v_mfma_f32_16x16x32_bf16 v[64:67], v[80:83], v[116:119], v[64:67]
  s_nop 0
  v_mfma_f32_16x16x32_bf16 v[68:71], v[84:87], v[116:119], v[68:71]
  v_accvgpr_read_b32 v104, a163
  v_accvgpr_read_b32 v105, a167
  v_accvgpr_read_b32 v106, a171
  v_accvgpr_read_b32 v107, a175
  v_accvgpr_read_b32 v108, a179
  v_accvgpr_read_b32 v109, a183
  v_accvgpr_read_b32 v110, a187
  v_accvgpr_read_b32 v111, a191
  v_perm_b32 v88, v105, v104, s74
  v_perm_b32 v89, v107, v106, s74
  v_perm_b32 v90, v109, v108, s74
  v_perm_b32 v91, v111, v110, s74
  v_perm_b32 v92, v105, v104, s75
  v_perm_b32 v93, v107, v106, s75
  v_perm_b32 v94, v109, v108, s75
  v_perm_b32 v95, v111, v110, s75
  v_mfma_f32_16x16x32_bf16 v[72:75], v[88:91], v[116:119], v[72:75]
  s_nop 0
  v_mfma_f32_16x16x32_bf16 v[76:79], v[92:95], v[116:119], v[76:79]
  s_waitcnt vmcnt(9)
  s_add_u32 s14, s14, s16
  s_cmp_lg_u32 s5, 0
  s_cbranch_scc1 Lw_25
Lw_24:
  s_memrealtime vcc
  s_waitcnt lgkmcnt(0)
  s_sub_u32 vcc_lo, vcc_lo, s14
  s_cmp_ge_i32 vcc_lo, -290
  s_cbranch_scc1 Lw_25
  s_sleep 2
  s_branch Lw_24
Lw_25:
  s_barrier
  s_add_u32 s73, s72, 10485760
  buffer_load_dwordx4 a[64:67], v2, s[36:39], s73 offen nt
  s_add_u32 s73, s72, 10489856
  buffer_load_dwordx4 a[68:71], v2, s[36:39], s73 offen nt
  s_add_u32 s73, s72, 10493952
  buffer_load_dwordx4 a[72:75], v2, s[36:39], s73 offen nt
  s_add_u32 s73, s72, 10498048
  buffer_load_dwordx4 a[76:79], v2, s[36:39], s73 offen nt
  s_add_u32 s73, s72, 10502144
  buffer_load_dwordx4 a[80:83], v2, s[36:39], s73 offen nt
  s_add_u32 s73, s72, 10506240
  buffer_load_dwordx4 a[84:87], v2, s[36:39], s73 offen nt
  s_add_u32 s73, s72, 10510336
  buffer_load_dwordx4 a[88:91], v2, s[36:39], s73 offen nt
  s_add_u32 s73, s72, 10514432
  buffer_load_dwordx4 a[92:95], v2, s[36:39], s73 offen nt
  v_mov_b32_dpp v112, v24 row_ror:8 row_mask:0xf bank_mask:0xf
  v_mov_b32_dpp v113, v25 row_ror:8 row_mask:0xf bank_mask:0xf
  v_mov_b32_dpp v114, v26 row_ror:8 row_mask:0xf bank_mask:0xf
  v_mov_b32_dpp v115, v27 row_ror:8 row_mask:0xf bank_mask:0xf
  v_accvgpr_read_b32 v96, a192
  v_accvgpr_read_b32 v97, a196
  v_accvgpr_read_b32 v98, a200
  v_accvgpr_read_b32 v99, a204
  v_accvgpr_read_b32 v100, a208
  v_accvgpr_read_b32 v101, a212
  v_accvgpr_read_b32 v102, a216
  v_accvgpr_read_b32 v103, a220
  v_perm_b32 v80, v97, v96, s74
  v_perm_b32 v81, v99, v98, s74
  v_perm_b32 v82, v101, v100, s74
  v_perm_b32 v83, v103, v102, s74
  v_perm_b32 v84, v97, v96, s75
  v_perm_b32 v85, v99, v98, s75
  v_perm_b32 v86, v101, v100, s75
  v_perm_b32 v87, v103, v102, s75
  v_mfma_f32_16x16x32_bf16 v[48:51], v[80:83], v[112:115], v[48:51]
  s_nop 0
  v_mfma_f32_16x16x32_bf16 v[52:55], v[84:87], v[112:115], v[52:55]
  v_accvgpr_read_b32 v104, a193
  v_accvgpr_read_b32 v105, a197
  v_accvgpr_read_b32 v106, a201
  v_accvgpr_read_b32 v107, a205
  v_accvgpr_read_b32 v108, a209
  v_accvgpr_read_b32 v109, a213
  v_accvgpr_read_b32 v110, a217
  v_accvgpr_read_b32 v111, a221
  v_perm_b32 v88, v105, v104, s74
  v_perm_b32 v89, v107, v106, s74
  v_perm_b32 v90, v109, v108, s74
  v_perm_b32 v91, v111, v110, s74
  v_perm_b32 v92, v105, v104, s75
  v_perm_b32 v93, v107, v106, s75
  v_perm_b32 v94, v109, v108, s75
  v_perm_b32 v95, v111, v110, s75
  v_mfma_f32_16x16x32_bf16 v[56:59], v[88:91], v[112:115], v[56:59]
  s_nop 0
  v_mfma_f32_16x16x32_bf16 v[60:63], v[92:95], v[112:115], v[60:63]
  v_accvgpr_read_b32 v96, a194
  v_accvgpr_read_b32 v97, a198
  v_accvgpr_read_b32 v98, a202
  v_accvgpr_read_b32 v99, a206
  v_accvgpr_read_b32 v100, a210
  v_accvgpr_read_b32 v101, a214
  v_accvgpr_read_b32 v102, a218
  v_accvgpr_read_b32 v103, a222
  v_perm_b32 v80, v97, v96, s74
  v_perm_b32 v81, v99, v98, s74
  v_perm_b32 v82, v101, v100, s74
  v_perm_b32 v83, v103, v102, s74
  v_perm_b32 v84, v97, v96, s75
  v_perm_b32 v85, v99, v98, s75
  v_perm_b32 v86, v101, v100, s75
  v_perm_b32 v87, v103, v102, s75
  v_mfma_f32_16x16x32_bf16 v[64:67], v[80:83], v[112:115], v[64:67]
  s_nop 0
  v_mfma_f32_16x16x32_bf16 v[68:71], v[84:87], v[112:115], v[68:71]
  v_accvgpr_read_b32 v104, a195
  v_accvgpr_read_b32 v105, a199
  v_accvgpr_read_b32 v106, a203
  v_accvgpr_read_b32 v107, a207
  v_accvgpr_read_b32 v108, a211
  v_accvgpr_read_b32 v109, a215
  v_accvgpr_read_b32 v110, a219
  v_accvgpr_read_b32 v111, a223
  v_perm_b32 v88, v105, v104, s74
  v_perm_b32 v89, v107, v106, s74
  v_perm_b32 v90, v109, v108, s74
  v_perm_b32 v91, v111, v110, s74
  v_perm_b32 v92, v105, v104, s75
  v_perm_b32 v93, v107, v106, s75
  v_perm_b32 v94, v109, v108, s75
  v_perm_b32 v95, v111, v110, s75
  v_mfma_f32_16x16x32_bf16 v[72:75], v[88:91], v[112:115], v[72:75]
  s_nop 0
  v_mfma_f32_16x16x32_bf16 v[76:79], v[92:95], v[112:115], v[76:79]
  v_mov_b32_dpp v116, v24 row_ror:4 row_mask:0xf bank_mask:0xf
  v_mov_b32_dpp v117, v25 row_ror:4 row_mask:0xf bank_mask:0xf
  v_mov_b32_dpp v118, v26 row_ror:4 row_mask:0xf bank_mask:0xf
  v_mov_b32_dpp v119, v27 row_ror:4 row_mask:0xf bank_mask:0xf
  v_accvgpr_read_b32 v96, a224
  v_accvgpr_read_b32 v97, a228
  v_accvgpr_read_b32 v98, a232
  v_accvgpr_read_b32 v99, a236
  v_accvgpr_read_b32 v100, a240
  v_accvgpr_read_b32 v101, a244
  v_accvgpr_read_b32 v102, a248
  v_accvgpr_read_b32 v103, a252
  v_perm_b32 v80, v97, v96, s74
  v_perm_b32 v81, v99, v98, s74
  v_perm_b32 v82, v101, v100, s74
  v_perm_b32 v83, v103, v102, s74
  v_perm_b32 v84, v97, v96, s75
  v_perm_b32 v85, v99, v98, s75
  v_perm_b32 v86, v101, v100, s75
  v_perm_b32 v87, v103, v102, s75
  v_mfma_f32_16x16x32_bf16 v[48:51], v[80:83], v[116:119], v[48:51]
  s_nop 0
  v_mfma_f32_16x16x32_bf16 v[52:55], v[84:87], v[116:119], v[52:55]
  v_accvgpr_read_b32 v104, a225
  v_accvgpr_read_b32 v105, a229
  v_accvgpr_read_b32 v106, a233
  v_accvgpr_read_b32 v107, a237
  v_accvgpr_read_b32 v108, a241
  v_accvgpr_read_b32 v109, a245
  v_accvgpr_read_b32 v110, a249
  v_accvgpr_read_b32 v111, a253
  v_perm_b32 v88, v105, v104, s74
  v_perm_b32 v89, v107, v106, s74
  v_perm_b32 v90, v109, v108, s74
  v_perm_b32 v91, v111, v110, s74
  v_perm_b32 v92, v105, v104, s75
  v_perm_b32 v93, v107, v106, s75
  v_perm_b32 v94, v109, v108, s75
  v_perm_b32 v95, v111, v110, s75
  v_mfma_f32_16x16x32_bf16 v[56:59], v[88:91], v[116:119], v[56:59]
  s_nop 0
  v_mfma_f32_16x16x32_bf16 v[60:63], v[92:95], v[116:119], v[60:63]
  v_accvgpr_read_b32 v96, a226
  v_accvgpr_read_b32 v97, a230
  v_accvgpr_read_b32 v98, a234
  v_accvgpr_read_b32 v99, a238
  v_accvgpr_read_b32 v100, a242
  v_accvgpr_read_b32 v101, a246
  v_accvgpr_read_b32 v102, a250
  v_accvgpr_read_b32 v103, a254
  v_perm_b32 v80, v97, v96, s74
  v_perm_b32 v81, v99, v98, s74
  v_perm_b32 v82, v101, v100, s74
  v_perm_b32 v83, v103, v102, s74
  v_perm_b32 v84, v97, v96, s75
  v_perm_b32 v85, v99, v98, s75
  v_perm_b32 v86, v101, v100, s75
  v_perm_b32 v87, v103, v102, s75
  v_mfma_f32_16x16x32_bf16 v[64:67], v[80:83], v[116:119], v[64:67]
  s_nop 0
  v_mfma_f32_16x16x32_bf16 v[68:71], v[84:87], v[116:119], v[68:71]
  v_accvgpr_read_b32 v104, a227
  v_accvgpr_read_b32 v105, a231
  v_accvgpr_read_b32 v106, a235
  v_accvgpr_read_b32 v107, a239
  v_accvgpr_read_b32 v108, a243
  v_accvgpr_read_b32 v109, a247
  v_accvgpr_read_b32 v110, a251
  v_accvgpr_read_b32 v111, a255
  v_perm_b32 v88, v105, v104, s74
  v_perm_b32 v89, v107, v106, s74
  v_perm_b32 v90, v109, v108, s74
  v_perm_b32 v91, v111, v110, s74
  v_perm_b32 v92, v105, v104, s75
  v_perm_b32 v93, v107, v106, s75
  v_perm_b32 v94, v109, v108, s75
  v_perm_b32 v95, v111, v110, s75
  v_mfma_f32_16x16x32_bf16 v[72:75], v[88:91], v[116:119], v[72:75]
  s_nop 0
  v_mfma_f32_16x16x32_bf16 v[76:79], v[92:95], v[116:119], v[76:79]
  v_accvgpr_read_b32 v96, a0
  v_accvgpr_read_b32 v97, a4
  v_accvgpr_read_b32 v98, a8
  v_accvgpr_read_b32 v99, a12
  v_accvgpr_read_b32 v100, a16
  v_accvgpr_read_b32 v101, a20
  v_accvgpr_read_b32 v102, a24
  v_accvgpr_read_b32 v103, a28
  v_perm_b32 v80, v97, v96, s74
  v_perm_b32 v81, v99, v98, s74
  v_perm_b32 v82, v101, v100, s74
  v_perm_b32 v83, v103, v102, s74
  v_perm_b32 v84, v97, v96, s75
  v_perm_b32 v85, v99, v98, s75
  v_perm_b32 v86, v101, v100, s75
  v_perm_b32 v87, v103, v102, s75
  v_mfma_f32_16x16x32_bf16 v[48:51], v[80:83], v[32:35], v[48:51]
  s_nop 0
  v_mfma_f32_16x16x32_bf16 v[52:55], v[84:87], v[32:35], v[52:55]
  v_accvgpr_read_b32 v104, a1
  v_accvgpr_read_b32 v105, a5
  v_accvgpr_read_b32 v106, a9
  v_accvgpr_read_b32 v107, a13
  v_accvgpr_read_b32 v108, a17
  v_accvgpr_read_b32 v109, a21
  v_accvgpr_read_b32 v110, a25
  v_accvgpr_read_b32 v111, a29
  v_perm_b32 v88, v105, v104, s74
  v_perm_b32 v89, v107, v106, s74
  v_perm_b32 v90, v109, v108, s74
  v_perm_b32 v91, v111, v110, s74
  v_perm_b32 v92, v105, v104, s75
  v_perm_b32 v93, v107, v106, s75
  v_perm_b32 v94, v109, v108, s75
  v_perm_b32 v95, v111, v110, s75
  v_mfma_f32_16x16x32_bf16 v[56:59], v[88:91], v[32:35], v[56:59]
  s_nop 0
  v_mfma_f32_16x16x32_bf16 v[60:63], v[92:95], v[32:35], v[60:63]
  v_accvgpr_read_b32 v96, a2
  v_accvgpr_read_b32 v97, a6
  v_accvgpr_read_b32 v98, a10
  v_accvgpr_read_b32 v99, a14
  v_accvgpr_read_b32 v100, a18
  v_accvgpr_read_b32 v101, a22
  v_accvgpr_read_b32 v102, a26
  v_accvgpr_read_b32 v103, a30
  v_perm_b32 v80, v97, v96, s74
  v_perm_b32 v81, v99, v98, s74
  v_perm_b32 v82, v101, v100, s74
  v_perm_b32 v83, v103, v102, s74
  v_perm_b32 v84, v97, v96, s75
  v_perm_b32 v85, v99, v98, s75
  v_perm_b32 v86, v101, v100, s75
  v_perm_b32 v87, v103, v102, s75
  v_mfma_f32_16x16x32_bf16 v[64:67], v[80:83], v[32:35], v[64:67]
  s_nop 0
  v_mfma_f32_16x16x32_bf16 v[68:71], v[84:87], v[32:35], v[68:71]
  v_accvgpr_read_b32 v104, a3
  v_accvgpr_read_b32 v105, a7
  v_accvgpr_read_b32 v106, a11
  v_accvgpr_read_b32 v107, a15
  v_accvgpr_read_b32 v108, a19
  v_accvgpr_read_b32 v109, a23
  v_accvgpr_read_b32 v110, a27
  v_accvgpr_read_b32 v111, a31
  v_perm_b32 v88, v105, v104, s74
  v_perm_b32 v89, v107, v106, s74
  v_perm_b32 v90, v109, v108, s74
  v_perm_b32 v91, v111, v110, s74
  v_perm_b32 v92, v105, v104, s75
  v_perm_b32 v93, v107, v106, s75
  v_perm_b32 v94, v109, v108, s75
  v_perm_b32 v95, v111, v110, s75
  v_mfma_f32_16x16x32_bf16 v[72:75], v[88:91], v[32:35], v[72:75]
  s_nop 0
  v_mfma_f32_16x16x32_bf16 v[76:79], v[92:95], v[32:35], v[76:79]
  s_waitcnt vmcnt(9)
  s_add_u32 s14, s14, s16
  s_cmp_lg_u32 s5, 0
  s_cbranch_scc1 Lw_27
Lw_26:
  s_memrealtime vcc
  s_waitcnt lgkmcnt(0)
  s_sub_u32 vcc_lo, vcc_lo, s14
  s_cmp_ge_i32 vcc_lo, -290
  s_cbranch_scc1 Lw_27
  s_sleep 2
  s_branch Lw_26
Lw_27:
  s_add_u32 s73, s72, 10518528
  buffer_load_dwordx4 a[96:99], v2, s[36:39], s73 offen nt
  s_add_u32 s73, s72, 10522624
  buffer_load_dwordx4 a[100:103], v2, s[36:39], s73 offen nt
  s_add_u32 s73, s72, 10526720
  buffer_load_dwordx4 a[104:107], v2, s[36:39], s73 offen nt
  s_add_u32 s73, s72, 10530816
  buffer_load_dwordx4 a[108:111], v2, s[36:39], s73 offen nt
  s_add_u32 s73, s72, 10534912
  buffer_load_dwordx4 a[112:115], v2, s[36:39], s73 offen nt
  s_add_u32 s73, s72, 10539008
  buffer_load_dwordx4 a[116:119], v2, s[36:39], s73 offen nt
  s_add_u32 s73, s72, 10543104
  buffer_load_dwordx4 a[120:123], v2, s[36:39], s73 offen nt
  s_add_u32 s73, s72, 10547200
  buffer_load_dwordx4 a[124:127], v2, s[36:39], s73 offen nt
  v_mov_b32_dpp v116, v32 row_ror:12 row_mask:0xf bank_mask:0xf
  v_mov_b32_dpp v117, v33 row_ror:12 row_mask:0xf bank_mask:0xf
  v_mov_b32_dpp v118, v34 row_ror:12 row_mask:0xf bank_mask:0xf
  v_mov_b32_dpp v119, v35 row_ror:12 row_mask:0xf bank_mask:0xf
  v_accvgpr_read_b32 v96, a32
  v_accvgpr_read_b32 v97, a36
  v_accvgpr_read_b32 v98, a40
  v_accvgpr_read_b32 v99, a44
  v_accvgpr_read_b32 v100, a48
  v_accvgpr_read_b32 v101, a52
  v_accvgpr_read_b32 v102, a56
  v_accvgpr_read_b32 v103, a60
  v_perm_b32 v80, v97, v96, s74
  v_perm_b32 v81, v99, v98, s74
  v_perm_b32 v82, v101, v100, s74
  v_perm_b32 v83, v103, v102, s74
  v_perm_b32 v84, v97, v96, s75
  v_perm_b32 v85, v99, v98, s75
  v_perm_b32 v86, v101, v100, s75
  v_perm_b32 v87, v103, v102, s75
  v_mfma_f32_16x16x32_bf16 v[48:51], v[80:83], v[116:119], v[48:51]
  s_nop 0
  v_mfma_f32_16x16x32_bf16 v[52:55], v[84:87], v[116:119], v[52:55]
  v_accvgpr_read_b32 v104, a33
  v_accvgpr_read_b32 v105, a37
  v_accvgpr_read_b32 v106, a41
  v_accvgpr_read_b32 v107, a45
  v_accvgpr_read_b32 v108, a49
  v_accvgpr_read_b32 v109, a53
  v_accvgpr_read_b32 v110, a57
  v_accvgpr_read_b32 v111, a61
  v_perm_b32 v88, v105, v104, s74
  v_perm_b32 v89, v107, v106, s74
  v_perm_b32 v90, v109, v108, s74
  v_perm_b32 v91, v111, v110, s74
  v_perm_b32 v92, v105, v104, s75
  v_perm_b32 v93, v107, v106, s75
  v_perm_b32 v94, v109, v108, s75
  v_perm_b32 v95, v111, v110, s75
  v_mfma_f32_16x16x32_bf16 v[56:59], v[88:91], v[116:119], v[56:59]
  s_nop 0
  v_mfma_f32_16x16x32_bf16 v[60:63], v[92:95], v[116:119], v[60:63]
  v_accvgpr_read_b32 v96, a34
  v_accvgpr_read_b32 v97, a38
  v_accvgpr_read_b32 v98, a42
  v_accvgpr_read_b32 v99, a46
  v_accvgpr_read_b32 v100, a50
  v_accvgpr_read_b32 v101, a54
  v_accvgpr_read_b32 v102, a58
  v_accvgpr_read_b32 v103, a62
  v_perm_b32 v80, v97, v96, s74
  v_perm_b32 v81, v99, v98, s74
  v_perm_b32 v82, v101, v100, s74
  v_perm_b32 v83, v103, v102, s74
  v_perm_b32 v84, v97, v96, s75
  v_perm_b32 v85, v99, v98, s75
  v_perm_b32 v86, v101, v100, s75
  v_perm_b32 v87, v103, v102, s75
  v_mfma_f32_16x16x32_bf16 v[64:67], v[80:83], v[116:119], v[64:67]
  s_nop 0
  v_mfma_f32_16x16x32_bf16 v[68:71], v[84:87], v[116:119], v[68:71]
  v_accvgpr_read_b32 v104, a35
  v_accvgpr_read_b32 v105, a39
  v_accvgpr_read_b32 v106, a43
  v_accvgpr_read_b32 v107, a47
  v_accvgpr_read_b32 v108, a51
  v_accvgpr_read_b32 v109, a55
  v_accvgpr_read_b32 v110, a59
  v_accvgpr_read_b32 v111, a63
  v_perm_b32 v88, v105, v104, s74
  v_perm_b32 v89, v107, v106, s74
  v_perm_b32 v90, v109, v108, s74
  v_perm_b32 v91, v111, v110, s74
  v_perm_b32 v92, v105, v104, s75
  v_perm_b32 v93, v107, v106, s75
  v_perm_b32 v94, v109, v108, s75
  v_perm_b32 v95, v111, v110, s75
  v_mfma_f32_16x16x32_bf16 v[72:75], v[88:91], v[116:119], v[72:75]
  s_nop 0
  v_mfma_f32_16x16x32_bf16 v[76:79], v[92:95], v[116:119], v[76:79]
  s_waitcnt vmcnt(8)
  s_add_u32 s14, s14, s16
  s_cmp_lg_u32 s5, 0
  s_cbranch_scc1 Lw_29
Lw_28:
  s_memrealtime vcc
  s_waitcnt lgkmcnt(0)
  s_sub_u32 vcc_lo, vcc_lo, s14
  s_cmp_ge_i32 vcc_lo, -290
  s_cbranch_scc1 Lw_29
  s_sleep 2
  s_branch Lw_28
Lw_29:
  s_barrier
  s_add_u32 s73, s72, 12582912
  buffer_load_dwordx4 v[128:131], v2, s[36:39], s73 offen nt
  s_add_u32 s73, s72, 12587008
  buffer_load_dwordx4 v[132:135], v2, s[36:39], s73 offen nt
  s_add_u32 s73, s72, 12591104
  buffer_load_dwordx4 v[136:139], v2, s[36:39], s73 offen nt
  s_add_u32 s73, s72, 12595200
  buffer_load_dwordx4 v[140:143], v2, s[36:39], s73 offen nt
  s_add_u32 s73, s72, 12599296
  buffer_load_dwordx4 v[144:147], v2, s[36:39], s73 offen nt
  s_add_u32 s73, s72, 12603392
  buffer_load_dwordx4 v[148:151], v2, s[36:39], s73 offen nt
  s_add_u32 s73, s72, 12607488
  buffer_load_dwordx4 v[152:155], v2, s[36:39], s73 offen nt
  s_add_u32 s73, s72, 12611584
  buffer_load_dwordx4 v[156:159], v2, s[36:39], s73 offen nt
  v_mov_b32_dpp v112, v32 row_ror:8 row_mask:0xf bank_mask:0xf
  v_mov_b32_dpp v113, v33 row_ror:8 row_mask:0xf bank_mask:0xf
  v_mov_b32_dpp v114, v34 row_ror:8 row_mask:0xf bank_mask:0xf
  v_mov_b32_dpp v115, v35 row_ror:8 row_mask:0xf bank_mask:0xf
  v_accvgpr_read_b32 v96, a64
  v_accvgpr_read_b32 v97, a68
  v_accvgpr_read_b32 v98, a72
  v_accvgpr_read_b32 v99, a76
  v_accvgpr_read_b32 v100, a80
  v_accvgpr_read_b32 v101, a84
  v_accvgpr_read_b32 v102, a88
  v_accvgpr_read_b32 v103, a92
  v_perm_b32 v80, v97, v96, s74
  v_perm_b32 v81, v99, v98, s74
  v_perm_b32 v82, v101, v100, s74
  v_perm_b32 v83, v103, v102, s74
  v_perm_b32 v84, v97, v96, s75
  v_perm_b32 v85, v99, v98, s75
  v_perm_b32 v86, v101, v100, s75
  v_perm_b32 v87, v103, v102, s75
  v_mfma_f32_16x16x32_bf16 v[48:51], v[80:83], v[112:115], v[48:51]
  s_nop 0
  v_mfma_f32_16x16x32_bf16 v[52:55], v[84:87], v[112:115], v[52:55]
  v_accvgpr_read_b32 v104, a65
  v_accvgpr_read_b32 v105, a69
  v_accvgpr_read_b32 v106, a73
  v_accvgpr_read_b32 v107, a77
  v_accvgpr_read_b32 v108, a81
  v_accvgpr_read_b32 v109, a85
  v_accvgpr_read_b32 v110, a89
  v_accvgpr_read_b32 v111, a93
  v_perm_b32 v88, v105, v104, s74
  v_perm_b32 v89, v107, v106, s74
  v_perm_b32 v90, v109, v108, s74
  v_perm_b32 v91, v111, v110, s74
  v_perm_b32 v92, v105, v104, s75
  v_perm_b32 v93, v107, v106, s75
  v_perm_b32 v94, v109, v108, s75
  v_perm_b32 v95, v111, v110, s75
  v_mfma_f32_16x16x32_bf16 v[56:59], v[88:91], v[112:115], v[56:59]
  s_nop 0
  v_mfma_f32_16x16x32_bf16 v[60:63], v[92:95], v[112:115], v[60:63]
  v_accvgpr_read_b32 v96, a66
  v_accvgpr_read_b32 v97, a70
  v_accvgpr_read_b32 v98, a74
  v_accvgpr_read_b32 v99, a78
  v_accvgpr_read_b32 v100, a82
  v_accvgpr_read_b32 v101, a86
  v_accvgpr_read_b32 v102, a90
  v_accvgpr_read_b32 v103, a94
  v_perm_b32 v80, v97, v96, s74
  v_perm_b32 v81, v99, v98, s74
  v_perm_b32 v82, v101, v100, s74
  v_perm_b32 v83, v103, v102, s74
  v_perm_b32 v84, v97, v96, s75
  v_perm_b32 v85, v99, v98, s75
  v_perm_b32 v86, v101, v100, s75
  v_perm_b32 v87, v103, v102, s75
  v_mfma_f32_16x16x32_bf16 v[64:67], v[80:83], v[112:115], v[64:67]
  s_nop 0
  v_mfma_f32_16x16x32_bf16 v[68:71], v[84:87], v[112:115], v[68:71]
  v_accvgpr_read_b32 v104, a67
  v_accvgpr_read_b32 v105, a71
  v_accvgpr_read_b32 v106, a75
  v_accvgpr_read_b32 v107, a79
  v_accvgpr_read_b32 v108, a83
  v_accvgpr_read_b32 v109, a87
  v_accvgpr_read_b32 v110, a91
  v_accvgpr_read_b32 v111, a95
  v_perm_b32 v88, v105, v104, s74
  v_perm_b32 v89, v107, v106, s74
  v_perm_b32 v90, v109, v108, s74
  v_perm_b32 v91, v111, v110, s74
  v_perm_b32 v92, v105, v104, s75
  v_perm_b32 v93, v107, v106, s75
  v_perm_b32 v94, v109, v108, s75
  v_perm_b32 v95, v111, v110, s75
  v_mfma_f32_16x16x32_bf16 v[72:75], v[88:91], v[112:115], v[72:75]
  s_nop 0
  v_mfma_f32_16x16x32_bf16 v[76:79], v[92:95], v[112:115], v[76:79]
  s_waitcnt vmcnt(8)
  s_add_u32 s73, s72, 12615680
  buffer_load_dwordx4 v[160:163], v2, s[36:39], s73 offen nt
  s_add_u32 s73, s72, 12619776
  buffer_load_dwordx4 v[164:167], v2, s[36:39], s73 offen nt
  s_add_u32 s73, s72, 12623872
  buffer_load_dwordx4 v[168:171], v2, s[36:39], s73 offen nt
  s_add_u32 s73, s72, 12627968
  buffer_load_dwordx4 v[172:175], v2, s[36:39], s73 offen nt
  s_add_u32 s73, s72, 12632064
  buffer_load_dwordx4 v[176:179], v2, s[36:39], s73 offen nt
  s_add_u32 s73, s72, 12636160
  buffer_load_dwordx4 v[180:183], v2, s[36:39], s73 offen nt
  s_add_u32 s73, s72, 12640256
  buffer_load_dwordx4 v[184:187], v2, s[36:39], s73 offen nt
  s_add_u32 s73, s72, 12644352
  buffer_load_dwordx4 v[188:191], v2, s[36:39], s73 offen nt
  v_xor_b32 v120, s31, v124
  v_xor_b32 v121, s31, v125
  v_or_b32 v120, v120, v121
  v_xor_b32 v121, s31, v126
  v_or_b32 v120, v120, v121
  v_xor_b32 v121, s31, v127
  v_or_b32 v120, v120, v121
  v_cmp_ne_u32 s[86:87], 0, v120
  s_nop 0
  s_mov_b64 s[84:85], s[86:87]
  s_cmp_eq_u64 s[84:85], 0
  s_cbranch_scc1 Lpd_30
  s_mov_b32 s78, 200000
Lpr_31:
  s_cmp_eq_u64 s[86:87], 0
  s_cbranch_scc1 Lps_32
  s_mov_b64 exec, s[86:87]
  buffer_load_dwordx4 v[124:127], v2, s[40:43], s9 offen sc1
Lps_32:
  s_mov_b64 exec, -1
  s_waitcnt vmcnt(0)
  s_cmp_eq_u64 s[86:87], 0
  s_cbranch_scc1 Lpc_33
  v_xor_b32 v120, s31, v124
  v_xor_b32 v121, s31, v125
  v_or_b32 v120, v120, v121
  v_xor_b32 v121, s31, v126
  v_or_b32 v120, v120, v121
  v_xor_b32 v121, s31, v127
  v_or_b32 v120, v120, v121
  v_cmp_ne_u32 s[86:87], 0, v120
Lpc_33:
  s_nop 0
  s_mov_b64 s[84:85], s[86:87]
  s_cmp_eq_u64 s[84:85], 0
  s_cbranch_scc1 Lpd_30
  s_sub_u32 s78, s78, 1
  s_cmp_lg_u32 s78, 0
  s_cbranch_scc1 Lpr_31
Lpd_30:
  v_mov_b32_dpp v116, v32 row_ror:4 row_mask:0xf bank_mask:0xf
  v_mov_b32_dpp v117, v33 row_ror:4 row_mask:0xf bank_mask:0xf
  v_mov_b32_dpp v118, v34 row_ror:4 row_mask:0xf bank_mask:0xf
  v_mov_b32_dpp v119, v35 row_ror:4 row_mask:0xf bank_mask:0xf
  v_accvgpr_read_b32 v96, a96
  v_accvgpr_read_b32 v97, a100
  v_accvgpr_read_b32 v98, a104
  v_accvgpr_read_b32 v99, a108
  v_accvgpr_read_b32 v100, a112
  v_accvgpr_read_b32 v101, a116
  v_accvgpr_read_b32 v102, a120
  v_accvgpr_read_b32 v103, a124
  v_perm_b32 v80, v97, v96, s74
  v_perm_b32 v81, v99, v98, s74
  v_perm_b32 v82, v101, v100, s74
  v_perm_b32 v83, v103, v102, s74
  v_perm_b32 v84, v97, v96, s75
  v_perm_b32 v85, v99, v98, s75
  v_perm_b32 v86, v101, v100, s75
  v_perm_b32 v87, v103, v102, s75
  v_mfma_f32_16x16x32_bf16 v[48:51], v[80:83], v[116:119], v[48:51]
  s_nop 0
  v_mfma_f32_16x16x32_bf16 v[52:55], v[84:87], v[116:119], v[52:55]
  v_accvgpr_read_b32 v104, a97
  v_accvgpr_read_b32 v105, a101
  v_accvgpr_read_b32 v106, a105
  v_accvgpr_read_b32 v107, a109
  v_accvgpr_read_b32 v108, a113
  v_accvgpr_read_b32 v109, a117
  v_accvgpr_read_b32 v110, a121
  v_accvgpr_read_b32 v111, a125
  v_perm_b32 v88, v105, v104, s74
  v_perm_b32 v89, v107, v106, s74
  v_perm_b32 v90, v109, v108, s74
  v_perm_b32 v91, v111, v110, s74
  v_perm_b32 v92, v105, v104, s75
  v_perm_b32 v93, v107, v106, s75
  v_perm_b32 v94, v109, v108, s75
  v_perm_b32 v95, v111, v110, s75
  v_mfma_f32_16x16x32_bf16 v[56:59], v[88:91], v[116:119], v[56:59]
  s_nop 0
  v_mfma_f32_16x16x32_bf16 v[60:63], v[92:95], v[116:119], v[60:63]
  v_accvgpr_read_b32 v96, a98
  v_accvgpr_read_b32 v97, a102
  v_accvgpr_read_b32 v98, a106
  v_accvgpr_read_b32 v99, a110
  v_accvgpr_read_b32 v100, a114
  v_accvgpr_read_b32 v101, a118
  v_accvgpr_read_b32 v102, a122
  v_accvgpr_read_b32 v103, a126
  v_perm_b32 v80, v97, v96, s74
  v_perm_b32 v81, v99, v98, s74
  v_perm_b32 v82, v101, v100, s74
  v_perm_b32 v83, v103, v102, s74
  v_perm_b32 v84, v97, v96, s75
  v_perm_b32 v85, v99, v98, s75
  v_perm_b32 v86, v101, v100, s75
  v_perm_b32 v87, v103, v102, s75
  v_mfma_f32_16x16x32_bf16 v[64:67], v[80:83], v[116:119], v[64:67]
  s_nop 0
  v_mfma_f32_16x16x32_bf16 v[68:71], v[84:87], v[116:119], v[68:71]
  v_accvgpr_read_b32 v104, a99
  v_accvgpr_read_b32 v105, a103
  v_accvgpr_read_b32 v106, a107
  v_accvgpr_read_b32 v107, a111
  v_accvgpr_read_b32 v108, a115
  v_accvgpr_read_b32 v109, a119
  v_accvgpr_read_b32 v110, a123
  v_accvgpr_read_b32 v111, a127
  v_perm_b32 v88, v105, v104, s74
  v_perm_b32 v89, v107, v106, s74
  v_perm_b32 v90, v109, v108, s74
  v_perm_b32 v91, v111, v110, s74
  v_perm_b32 v92, v105, v104, s75
  v_perm_b32 v93, v107, v106, s75
  v_perm_b32 v94, v109, v108, s75
  v_perm_b32 v95, v111, v110, s75
  v_mfma_f32_16x16x32_bf16 v[72:75], v[88:91], v[116:119], v[72:75]
  s_nop 0
  v_mfma_f32_16x16x32_bf16 v[76:79], v[92:95], v[116:119], v[76:79]
  s_waitcnt vmcnt(8)
  s_barrier
  s_add_u32 s73, s72, 14680064
  buffer_load_dwordx4 v[192:195], v2, s[36:39], s73 offen nt
  s_add_u32 s73, s72, 14684160
  buffer_load_dwordx4 v[196:199], v2, s[36:39], s73 offen nt
  s_add_u32 s73, s72, 14688256
  buffer_load_dwordx4 v[200:203], v2, s[36:39], s73 offen nt
  s_add_u32 s73, s72, 14692352
  buffer_load_dwordx4 v[204:207], v2, s[36:39], s73 offen nt
  s_add_u32 s73, s72, 14696448
  buffer_load_dwordx4 v[208:211], v2, s[36:39], s73 offen nt
  s_add_u32 s73, s72, 14700544
  buffer_load_dwordx4 v[212:215], v2, s[36:39], s73 offen nt
  s_add_u32 s73, s72, 14704640
  buffer_load_dwordx4 v[216:219], v2, s[36:39], s73 offen nt
  s_add_u32 s73, s72, 14708736
  buffer_load_dwordx4 v[220:223], v2, s[36:39], s73 offen nt
  v_perm_b32 v80, v132, v128, s74
  v_perm_b32 v81, v140, v136, s74
  v_perm_b32 v82, v148, v144, s74
  v_perm_b32 v83, v156, v152, s74
  v_perm_b32 v84, v132, v128, s75
  v_perm_b32 v85, v140, v136, s75
  v_perm_b32 v86, v148, v144, s75
  v_perm_b32 v87, v156, v152, s75
  v_mfma_f32_16x16x32_bf16 v[48:51], v[80:83], v[40:43], v[48:51]
  s_nop 0
  v_mfma_f32_16x16x32_bf16 v[52:55], v[84:87], v[40:43], v[52:55]
  v_perm_b32 v88, v133, v129, s74
  v_perm_b32 v89, v141, v137, s74
  v_perm_b32 v90, v149, v145, s74
  v_perm_b32 v91, v157, v153, s74
  v_perm_b32 v92, v133, v129, s75
  v_perm_b32 v93, v141, v137, s75
  v_perm_b32 v94, v149, v145, s75
  v_perm_b32 v95, v157, v153, s75
  v_mfma_f32_16x16x32_bf16 v[56:59], v[88:91], v[40:43], v[56:59]
  s_nop 0
  v_mfma_f32_16x16x32_bf16 v[60:63], v[92:95], v[40:43], v[60:63]
  v_perm_b32 v80, v134, v130, s74
  v_perm_b32 v81, v142, v138, s74
  v_perm_b32 v82, v150, v146, s74
  v_perm_b32 v83, v158, v154, s74
  v_perm_b32 v84, v134, v130, s75
  v_perm_b32 v85, v142, v138, s75
  v_perm_b32 v86, v150, v146, s75
  v_perm_b32 v87, v158, v154, s75
  v_mfma_f32_16x16x32_bf16 v[64:67], v[80:83], v[40:43], v[64:67]
  s_nop 0
  v_mfma_f32_16x16x32_bf16 v[68:71], v[84:87], v[40:43], v[68:71]
  v_perm_b32 v88, v135, v131, s74
  v_perm_b32 v89, v143, v139, s74
  v_perm_b32 v90, v151, v147, s74
  v_perm_b32 v91, v159, v155, s74
  v_perm_b32 v92, v135, v131, s75
  v_perm_b32 v93, v143, v139, s75
  v_perm_b32 v94, v151, v147, s75
  v_perm_b32 v95, v159, v155, s75
  v_mfma_f32_16x16x32_bf16 v[72:75], v[88:91], v[40:43], v[72:75]
  s_nop 0
  v_mfma_f32_16x16x32_bf16 v[76:79], v[92:95], v[40:43], v[76:79]
  s_waitcnt vmcnt(8)
  s_add_u32 s73, s72, 14712832
  buffer_load_dwordx4 v[224:227], v2, s[36:39], s73 offen nt
  s_add_u32 s73, s72, 14716928
  buffer_load_dwordx4 v[228:231], v2, s[36:39], s73 offen nt
  s_add_u32 s73, s72, 14721024
  buffer_load_dwordx4 v[232:235], v2, s[36:39], s73 offen nt
  s_add_u32 s73, s72, 14725120
  buffer_load_dwordx4 v[236:239], v2, s[36:39], s73 offen nt
  s_add_u32 s73, s72, 14729216
  buffer_load_dwordx4 v[240:243], v2, s[36:39], s73 offen nt
  s_add_u32 s73, s72, 14733312
  buffer_load_dwordx4 v[244:247], v2, s[36:39], s73 offen nt
  s_add_u32 s73, s72, 14737408
  buffer_load_dwordx4 v[248:251], v2, s[36:39], s73 offen nt
  s_add_u32 s73, s72, 14741504
  buffer_load_dwordx4 v[252:255], v2, s[36:39], s73 offen nt
  s_barrier
  v_mov_b32_dpp v116, v40 row_ror:12 row_mask:0xf bank_mask:0xf
  v_mov_b32_dpp v117, v41 row_ror:12 row_mask:0xf bank_mask:0xf
  v_mov_b32_dpp v118, v42 row_ror:12 row_mask:0xf bank_mask:0xf
  v_mov_b32_dpp v119, v43 row_ror:12 row_mask:0xf bank_mask:0xf
  v_perm_b32 v80, v164, v160, s74
  v_perm_b32 v81, v172, v168, s74
  v_perm_b32 v82, v180, v176, s74
  v_perm_b32 v83, v188, v184, s74
  v_perm_b32 v84, v164, v160, s75
  v_perm_b32 v85, v172, v168, s75
  v_perm_b32 v86, v180, v176, s75
  v_perm_b32 v87, v188, v184, s75
  v_mfma_f32_16x16x32_bf16 v[48:51], v[80:83], v[116:119], v[48:51]
  s_nop 0
  v_mfma_f32_16x16x32_bf16 v[52:55], v[84:87], v[116:119], v[52:55]
  v_perm_b32 v88, v165, v161, s74
  v_perm_b32 v89, v173, v169, s74
  v_perm_b32 v90, v181, v177, s74
  v_perm_b32 v91, v189, v185, s74
  v_perm_b32 v92, v165, v161, s75
  v_perm_b32 v93, v173, v169, s75
  v_perm_b32 v94, v181, v177, s75
  v_perm_b32 v95, v189, v185, s75
  v_mfma_f32_16x16x32_bf16 v[56:59], v[88:91], v[116:119], v[56:59]
  s_nop 0
  v_mfma_f32_16x16x32_bf16 v[60:63], v[92:95], v[116:119], v[60:63]
  v_perm_b32 v80, v166, v162, s74
  v_perm_b32 v81, v174, v170, s74
  v_perm_b32 v82, v182, v178, s74
  v_perm_b32 v83, v190, v186, s74
  v_perm_b32 v84, v166, v162, s75
  v_perm_b32 v85, v174, v170, s75
  v_perm_b32 v86, v182, v178, s75
  v_perm_b32 v87, v190, v186, s75
  v_mfma_f32_16x16x32_bf16 v[64:67], v[80:83], v[116:119], v[64:67]
  s_nop 0
  v_mfma_f32_16x16x32_bf16 v[68:71], v[84:87], v[116:119], v[68:71]
  v_perm_b32 v88, v167, v163, s74
  v_perm_b32 v89, v175, v171, s74
  v_perm_b32 v90, v183, v179, s74
  v_perm_b32 v91, v191, v187, s74
  v_perm_b32 v92, v167, v163, s75
  v_perm_b32 v93, v175, v171, s75
  v_perm_b32 v94, v183, v179, s75
  v_perm_b32 v95, v191, v187, s75
  v_mfma_f32_16x16x32_bf16 v[72:75], v[88:91], v[116:119], v[72:75]
  s_nop 0
  v_mfma_f32_16x16x32_bf16 v[76:79], v[92:95], v[116:119], v[76:79]
  buffer_load_dwordx4 v[20:23], v12, s[52:55], s6 offen offset:0 nt
  s_add_u32 s73, s6, 8192
  buffer_load_dwordx4 v[160:163], v12, s[52:55], s73 offen offset:0 nt
  buffer_load_dwordx4 v[28:31], v12, s[52:55], s6 offen offset:1024 nt
  s_add_u32 s73, s6, 8192
  buffer_load_dwordx4 v[164:167], v12, s[52:55], s73 offen offset:1024 nt
  buffer_load_dwordx4 v[36:39], v12, s[52:55], s6 offen offset:2048 nt
  s_add_u32 s73, s6, 8192
  buffer_load_dwordx4 v[168:171], v12, s[52:55], s73 offen offset:2048 nt
  buffer_load_dwordx4 v[44:47], v12, s[52:55], s6 offen offset:3072 nt
  s_add_u32 s73, s6, 8192
  buffer_load_dwordx4 v[172:175], v12, s[52:55], s73 offen offset:3072 nt
  s_waitcnt vmcnt(16)
  v_mov_b32_dpp v112, v40 row_ror:8 row_mask:0xf bank_mask:0xf
  v_mov_b32_dpp v113, v41 row_ror:8 row_mask:0xf bank_mask:0xf
  v_mov_b32_dpp v114, v42 row_ror:8 row_mask:0xf bank_mask:0xf
  v_mov_b32_dpp v115, v43 row_ror:8 row_mask:0xf bank_mask:0xf
  v_perm_b32 v80, v196, v192, s74
  v_perm_b32 v81, v204, v200, s74
  v_perm_b32 v82, v212, v208, s74
  v_perm_b32 v83, v220, v216, s74
  v_perm_b32 v84, v196, v192, s75
  v_perm_b32 v85, v204, v200, s75
  v_perm_b32 v86, v212, v208, s75
  v_perm_b32 v87, v220, v216, s75
  v_mfma_f32_16x16x32_bf16 v[48:51], v[80:83], v[112:115], v[48:51]
  s_nop 0
  v_mfma_f32_16x16x32_bf16 v[52:55], v[84:87], v[112:115], v[52:55]
  v_perm_b32 v88, v197, v193, s74
  v_perm_b32 v89, v205, v201, s74
  v_perm_b32 v90, v213, v209, s74
  v_perm_b32 v91, v221, v217, s74
  v_perm_b32 v92, v197, v193, s75
  v_perm_b32 v93, v205, v201, s75
  v_perm_b32 v94, v213, v209, s75
  v_perm_b32 v95, v221, v217, s75
  v_mfma_f32_16x16x32_bf16 v[56:59], v[88:91], v[112:115], v[56:59]
  s_nop 0
  v_mfma_f32_16x16x32_bf16 v[60:63], v[92:95], v[112:115], v[60:63]
  v_perm_b32 v80, v198, v194, s74
  v_perm_b32 v81, v206, v202, s74
  v_perm_b32 v82, v214, v210, s74
  v_perm_b32 v83, v222, v218, s74
  v_perm_b32 v84, v198, v194, s75
  v_perm_b32 v85, v206, v202, s75
  v_perm_b32 v86, v214, v210, s75
  v_perm_b32 v87, v222, v218, s75
  v_mfma_f32_16x16x32_bf16 v[64:67], v[80:83], v[112:115], v[64:67]
  s_nop 0
  v_mfma_f32_16x16x32_bf16 v[68:71], v[84:87], v[112:115], v[68:71]
  v_perm_b32 v88, v199, v195, s74
  v_perm_b32 v89, v207, v203, s74
  v_perm_b32 v90, v215, v211, s74
  v_perm_b32 v91, v223, v219, s74
  v_perm_b32 v92, v199, v195, s75
  v_perm_b32 v93, v207, v203, s75
  v_perm_b32 v94, v215, v211, s75
  v_perm_b32 v95, v223, v219, s75
  v_mfma_f32_16x16x32_bf16 v[72:75], v[88:91], v[112:115], v[72:75]
  s_nop 0
  v_mfma_f32_16x16x32_bf16 v[76:79], v[92:95], v[112:115], v[76:79]
  s_waitcnt vmcnt(8)
  v_mov_b32_dpp v116, v40 row_ror:4 row_mask:0xf bank_mask:0xf
  v_mov_b32_dpp v117, v41 row_ror:4 row_mask:0xf bank_mask:0xf
  v_mov_b32_dpp v118, v42 row_ror:4 row_mask:0xf bank_mask:0xf
  v_mov_b32_dpp v119, v43 row_ror:4 row_mask:0xf bank_mask:0xf
  v_perm_b32 v80, v228, v224, s74
  v_perm_b32 v81, v236, v232, s74
  v_perm_b32 v82, v244, v240, s74
  v_perm_b32 v83, v252, v248, s74
  v_perm_b32 v84, v228, v224, s75
  v_perm_b32 v85, v236, v232, s75
  v_perm_b32 v86, v244, v240, s75
  v_perm_b32 v87, v252, v248, s75
  v_mfma_f32_16x16x32_bf16 v[48:51], v[80:83], v[116:119], v[48:51]
  s_nop 0
  v_mfma_f32_16x16x32_bf16 v[52:55], v[84:87], v[116:119], v[52:55]
  v_perm_b32 v88, v229, v225, s74
  v_perm_b32 v89, v237, v233, s74
  v_perm_b32 v90, v245, v241, s74
  v_perm_b32 v91, v253, v249, s74
  v_perm_b32 v92, v229, v225, s75
  v_perm_b32 v93, v237, v233, s75
  v_perm_b32 v94, v245, v241, s75
  v_perm_b32 v95, v253, v249, s75
  v_mfma_f32_16x16x32_bf16 v[56:59], v[88:91], v[116:119], v[56:59]
  s_nop 0
  v_mfma_f32_16x16x32_bf16 v[60:63], v[92:95], v[116:119], v[60:63]
  v_perm_b32 v80, v230, v226, s74
  v_perm_b32 v81, v238, v234, s74
  v_perm_b32 v82, v246, v242, s74
  v_perm_b32 v83, v254, v250, s74
  v_perm_b32 v84, v230, v226, s75
  v_perm_b32 v85, v238, v234, s75
  v_perm_b32 v86, v246, v242, s75
  v_perm_b32 v87, v254, v250, s75
  v_mfma_f32_16x16x32_bf16 v[64:67], v[80:83], v[116:119], v[64:67]
  s_nop 0
  v_mfma_f32_16x16x32_bf16 v[68:71], v[84:87], v[116:119], v[68:71]
  v_perm_b32 v88, v231, v227, s74
  v_perm_b32 v89, v239, v235, s74
  v_perm_b32 v90, v247, v243, s74
  v_perm_b32 v91, v255, v251, s74
  v_perm_b32 v92, v231, v227, s75
  v_perm_b32 v93, v239, v235, s75
  v_perm_b32 v94, v247, v243, s75
  v_perm_b32 v95, v255, v251, s75
  v_mfma_f32_16x16x32_bf16 v[72:75], v[88:91], v[116:119], v[72:75]
  s_nop 0
  v_mfma_f32_16x16x32_bf16 v[76:79], v[92:95], v[116:119], v[76:79]
Lwb:
  v_and_b32 v122, 3, v0
  v_lshrrev_b32 v1, 4, v0
  v_lshl_add_u32 v122, v122, 2, v1
  v_mul_u32_u24 v122, 144, v122
  s_mul_i32 s81, s3, 2304
  v_add_u32 v122, s81, v122
  s_and_b32 s82, s3, 1
  s_mul_i32 s81, s82, 1152
  v_lshrrev_b32 v123, 3, v0
  v_mul_u32_u24 v123, 144, v123
  v_and_b32 v1, 7, v0
  v_lshl_add_u32 v123, v1, 4, v123
  v_add_u32 v123, s81, v123
  s_mov_b32 exec_lo, 0x000f000f
  s_mov_b32 exec_hi, 0x000f000f
  ds_write_b128 v122, v[48:51] offset:1024
  ds_write_b128 v122, v[52:55] offset:1040
  ds_write_b128 v122, v[56:59] offset:1056
  ds_write_b128 v122, v[60:63] offset:1072
  ds_write_b128 v122, v[64:67] offset:1088
  ds_write_b128 v122, v[68:71] offset:1104
  ds_write_b128 v122, v[72:75] offset:1120
  ds_write_b128 v122, v[76:79] offset:1136
  s_mov_b64 exec, -1
  s_lshl_b32 s81, s28, 16
  s_add_u32 s83, s81, 65536
  s_lshl_b32 s81, s29, 11
  s_add_u32 s81, s81, s83
  s_lshl_b32 s82, s82, 10
  s_add_u32 s81, s81, s82
  s_waitcnt lgkmcnt(0)
  s_barrier
  s_cmp_gt_u32 s3, 1
  s_cbranch_scc1 Lo_34
  ds_read_b128 v[80:83], v123 offset:1024
  ds_read_b128 v[84:87], v123 offset:3328
  ds_read_b128 v[88:91], v123 offset:5632
  ds_read_b128 v[92:95], v123 offset:7936
  s_waitcnt lgkmcnt(2)
  v_pk_add_f32 v[80:81], v[80:81], v[84:85]
  v_pk_add_f32 v[82:83], v[82:83], v[86:87]
  s_waitcnt lgkmcnt(0)
  v_pk_add_f32 v[88:89], v[88:89], v[92:93]
  v_pk_add_f32 v[90:91], v[90:91], v[94:95]
  v_pk_add_f32 v[112:113], v[80:81], v[88:89]
  v_pk_add_f32 v[114:115], v[82:83], v[90:91]
  s_mov_b32 s24, s81
  s_cmp_eq_u32 s27, 0
  s_cbranch_scc1 Lg_35
  buffer_store_dwordx4 v[112:115], v2, s[40:43], s81 offen
  s_branch Lo_34
Lg_35:
  buffer_store_dwordx4 v[112:115], v2, s[40:43], s81 offen sc1
Lo_34:
  s_cmp_eq_u32 s5, 0
  s_cbranch_scc1 Lb_36
  s_barrier
Lb_36:
  s_add_u32 s73, s7, 0
  buffer_load_dwordx4 a[128:131], v13, s[56:59], s73 offen nt
  s_add_u32 s73, s7, 3584
  buffer_load_dwordx4 a[132:135], v13, s[56:59], s73 offen nt
  s_add_u32 s73, s7, 7168
  buffer_load_dwordx4 a[136:139], v13, s[56:59], s73 offen nt
  s_add_u32 s73, s7, 10752
  buffer_load_dwordx4 a[140:143], v13, s[56:59], s73 offen nt
  s_add_u32 s73, s7, 0
  buffer_load_dwordx4 a[144:147], v13, s[60:63], s73 offen nt
  s_add_u32 s73, s7, 3584
  buffer_load_dwordx4 a[148:151], v13, s[60:63], s73 offen nt
  s_add_u32 s73, s7, 7168
  buffer_load_dwordx4 a[152:155], v13, s[60:63], s73 offen nt
  s_add_u32 s73, s7, 10752
  buffer_load_dwordx4 a[156:159], v13, s[60:63], s73 offen nt
  buffer_load_dwordx4 a[160:163], v14, s[64:67], s8 offen offset:0 nt
  buffer_load_dwordx4 a[164:167], v14, s[64:67], s8 offen offset:1024 nt
  buffer_load_dwordx4 a[168:171], v14, s[64:67], s8 offen offset:2048 nt
  buffer_load_dwordx4 a[172:175], v14, s[64:67], s8 offen offset:3072 nt
  s_cmp_eq_u32 s11, 0
  s_cbranch_scc1 L_s3
  v_bfe_u32 v122, v0, 2, 2
  v_lshlrev_b32 v122, 11, v122
  v_lshrrev_b32 v1, 4, v0
  v_lshl_add_u32 v122, v1, 6, v122
  v_and_b32 v1, 3, v0
  v_lshl_add_u32 v122, v1, 4, v122
  s_lshr_b32 s81, s29, 4
  s_lshl_b32 s81, s81, 10
  s_add_u32 s83, s83, s81
  s_lshl_b32 s81, s3, 8
  s_add_u32 s83, s83, s81
  s_add_u32 s10, s83, 0
  s_add_u32 s11, s83, 8192
  s_add_u32 s12, s83, 16384
  s_add_u32 s13, s83, 24576
  s_add_u32 s14, s83, 32768
  s_add_u32 s15, s83, 40960
  s_add_u32 s16, s83, 49152
  s_add_u32 s17, s83, 57344
  buffer_load_dwordx4 v[128:131], v122, s[40:43], s10 offen sc1
  buffer_load_dwordx4 v[132:135], v122, s[40:43], s11 offen sc1
  buffer_load_dwordx4 v[136:139], v122, s[40:43], s12 offen sc1
  buffer_load_dwordx4 v[140:143], v122, s[40:43], s13 offen sc1
  buffer_load_dwordx4 v[144:147], v122, s[40:43], s14 offen sc1
  buffer_load_dwordx4 v[148:151], v122, s[40:43], s15 offen sc1
  buffer_load_dwordx4 v[152:155], v122, s[40:43], s16 offen sc1
  buffer_load_dwordx4 v[156:159], v122, s[40:43], s17 offen sc1
  v_and_b32 v123, 7, v0
  v_lshlrev_b32 v123, 5, v123
  v_lshrrev_b32 v1, 3, v0
  v_lshl_add_u32 v123, v1, 2, v123
  v_add_u32 v123, s81, v123
  s_waitcnt vmcnt(20)
  v_perm_b32 v48, v160, v20, s74
  v_perm_b32 v49, v160, v20, s75
  v_perm_b32 v50, v161, v21, s74
  v_perm_b32 v51, v161, v21, s75
  v_perm_b32 v52, v162, v22, s74
  v_perm_b32 v53, v162, v22, s75
  v_perm_b32 v54, v163, v23, s74
  v_perm_b32 v55, v163, v23, s75
  v_perm_b32 v56, v164, v28, s74
  v_perm_b32 v57, v164, v28, s75
  v_perm_b32 v58, v165, v29, s74
  v_perm_b32 v59, v165, v29, s75
  v_perm_b32 v60, v166, v30, s74
  v_perm_b32 v61, v166, v30, s75
  v_perm_b32 v62, v167, v31, s74
  v_perm_b32 v63, v167, v31, s75
  v_perm_b32 v64, v168, v36, s74
  v_perm_b32 v65, v168, v36, s75
  v_perm_b32 v66, v169, v37, s74
  v_perm_b32 v67, v169, v37, s75
  v_perm_b32 v68, v170, v38, s74
  v_perm_b32 v69, v170, v38, s75
  v_perm_b32 v70, v171, v39, s74
  v_perm_b32 v71, v171, v39, s75
  v_perm_b32 v72, v172, v44, s74
  v_perm_b32 v73, v172, v44, s75
  v_perm_b32 v74, v173, v45, s74
  v_perm_b32 v75, v173, v45, s75
  v_perm_b32 v76, v174, v46, s74
  v_perm_b32 v77, v174, v46, s75
  v_perm_b32 v78, v175, v47, s74
  v_perm_b32 v79, v175, v47, s75
  s_waitcnt vmcnt(0)
  v_max3_u32 v120, v128, v129, v130
  v_max_u32 v120, v120, v131
  v_cmp_eq_u32 s[86:87], -1, v120
  v_max3_u32 v121, v132, v133, v134
  v_max_u32 v121, v121, v135
  v_cmp_eq_u32 s[88:89], -1, v121
  v_max3_u32 v120, v136, v137, v138
  v_max_u32 v120, v120, v139
  v_cmp_eq_u32 s[90:91], -1, v120
  v_max3_u32 v121, v140, v141, v142
  v_max_u32 v121, v121, v143
  v_cmp_eq_u32 s[92:93], -1, v121
  v_max3_u32 v120, v144, v145, v146
  v_max_u32 v120, v120, v147
  v_cmp_eq_u32 s[94:95], -1, v120
  v_max3_u32 v121, v148, v149, v150
  v_max_u32 v121, v121, v151
  v_cmp_eq_u32 s[96:97], -1, v121
  v_max3_u32 v120, v152, v153, v154
  v_max_u32 v120, v120, v155
  v_cmp_eq_u32 s[98:99], -1, v120
  v_max3_u32 v121, v156, v157, v158
  v_max_u32 v121, v121, v159
  v_cmp_eq_u32 s[100:101], -1, v121
  s_or_b64 s[84:85], s[86:87], s[88:89]
  s_or_b64 s[84:85], s[84:85], s[90:91]
  s_or_b64 s[84:85], s[84:85], s[92:93]
  s_or_b64 s[84:85], s[84:85], s[94:95]
  s_or_b64 s[84:85], s[84:85], s[96:97]
  s_or_b64 s[84:85], s[84:85], s[98:99]
  s_or_b64 s[84:85], s[84:85], s[100:101]
  s_cmp_eq_u64 s[84:85], 0
  s_cbranch_scc1 Lpd_37
  s_mov_b32 s78, 200000
Lpr_38:
  s_cmp_eq_u64 s[86:87], 0
  s_cbranch_scc1 Lps_39
  s_mov_b64 exec, s[86:87]
  buffer_load_dwordx4 v[128:131], v122, s[40:43], s10 offen sc1
Lps_39:
  s_cmp_eq_u64 s[88:89], 0
  s_cbranch_scc1 Lps_40
  s_mov_b64 exec, s[88:89]
  buffer_load_dwordx4 v[132:135], v122, s[40:43], s11 offen sc1
Lps_40:
  s_cmp_eq_u64 s[90:91], 0
  s_cbranch_scc1 Lps_41
  s_mov_b64 exec, s[90:91]
  buffer_load_dwordx4 v[136:139], v122, s[40:43], s12 offen sc1
Lps_41:
  s_cmp_eq_u64 s[92:93], 0
  s_cbranch_scc1 Lps_42
  s_mov_b64 exec, s[92:93]
  buffer_load_dwordx4 v[140:143], v122, s[40:43], s13 offen sc1
Lps_42:
  s_cmp_eq_u64 s[94:95], 0
  s_cbranch_scc1 Lps_43
  s_mov_b64 exec, s[94:95]
  buffer_load_dwordx4 v[144:147], v122, s[40:43], s14 offen sc1
Lps_43:
  s_cmp_eq_u64 s[96:97], 0
  s_cbranch_scc1 Lps_44
  s_mov_b64 exec, s[96:97]
  buffer_load_dwordx4 v[148:151], v122, s[40:43], s15 offen sc1
Lps_44:
  s_cmp_eq_u64 s[98:99], 0
  s_cbranch_scc1 Lps_45
  s_mov_b64 exec, s[98:99]
  buffer_load_dwordx4 v[152:155], v122, s[40:43], s16 offen sc1
Lps_45:
  s_cmp_eq_u64 s[100:101], 0
  s_cbranch_scc1 Lps_46
  s_mov_b64 exec, s[100:101]
  buffer_load_dwordx4 v[156:159], v122, s[40:43], s17 offen sc1
Lps_46:
  s_mov_b64 exec, -1
  s_waitcnt vmcnt(0)
  s_cmp_eq_u64 s[86:87], 0
  s_cbranch_scc1 Lpc_47
  v_max3_u32 v120, v128, v129, v130
  v_max_u32 v120, v120, v131
  v_cmp_eq_u32 s[86:87], -1, v120
Lpc_47:
  s_cmp_eq_u64 s[88:89], 0
  s_cbranch_scc1 Lpc_48
  v_max3_u32 v121, v132, v133, v134
  v_max_u32 v121, v121, v135
  v_cmp_eq_u32 s[88:89], -1, v121
Lpc_48:
  s_cmp_eq_u64 s[90:91], 0
  s_cbranch_scc1 Lpc_49
  v_max3_u32 v120, v136, v137, v138
  v_max_u32 v120, v120, v139
  v_cmp_eq_u32 s[90:91], -1, v120
Lpc_49:
  s_cmp_eq_u64 s[92:93], 0
  s_cbranch_scc1 Lpc_50
  v_max3_u32 v121, v140, v141, v142
  v_max_u32 v121, v121, v143
  v_cmp_eq_u32 s[92:93], -1, v121
Lpc_50:
  s_cmp_eq_u64 s[94:95], 0
  s_cbranch_scc1 Lpc_51
  v_max3_u32 v120, v144, v145, v146
  v_max_u32 v120, v120, v147
  v_cmp_eq_u32 s[94:95], -1, v120
Lpc_51:
  s_cmp_eq_u64 s[96:97], 0
  s_cbranch_scc1 Lpc_52
  v_max3_u32 v121, v148, v149, v150
  v_max_u32 v121, v121, v151
  v_cmp_eq_u32 s[96:97], -1, v121
Lpc_52:
  s_cmp_eq_u64 s[98:99], 0
  s_cbranch_scc1 Lpc_53
  v_max3_u32 v120, v152, v153, v154
  v_max_u32 v120, v120, v155
  v_cmp_eq_u32 s[98:99], -1, v120
Lpc_53:
  s_cmp_eq_u64 s[100:101], 0
  s_cbranch_scc1 Lpc_54
  v_max3_u32 v121, v156, v157, v158
  v_max_u32 v121, v121, v159
  v_cmp_eq_u32 s[100:101], -1, v121
Lpc_54:
  s_or_b64 s[84:85], s[86:87], s[88:89]
  s_or_b64 s[84:85], s[84:85], s[90:91]
  s_or_b64 s[84:85], s[84:85], s[92:93]
  s_or_b64 s[84:85], s[84:85], s[94:95]
  s_or_b64 s[84:85], s[84:85], s[96:97]
  s_or_b64 s[84:85], s[84:85], s[98:99]
  s_or_b64 s[84:85], s[84:85], s[100:101]
  s_cmp_eq_u64 s[84:85], 0
  s_cbranch_scc1 Lpd_37
  s_sub_u32 s78, s78, 1
  s_cmp_lg_u32 s78, 0
  s_cbranch_scc1 Lpr_38
Lpd_37:
  v_pk_add_f32 v[128:129], v[128:129], v[144:145]
  v_pk_add_f32 v[130:131], v[130:131], v[146:147]
  v_pk_add_f32 v[132:133], v[132:133], v[148:149]
  v_pk_add_f32 v[134:135], v[134:135], v[150:151]
  v_pk_add_f32 v[136:137], v[136:137], v[152:153]
  v_pk_add_f32 v[138:139], v[138:139], v[154:155]
  v_pk_add_f32 v[140:141], v[140:141], v[156:157]
  v_pk_add_f32 v[142:143], v[142:143], v[158:159]
  v_pk_add_f32 v[128:129], v[128:129], v[136:137]
  v_pk_add_f32 v[130:131], v[130:131], v[138:139]
  v_pk_add_f32 v[132:133], v[132:133], v[140:141]
  v_pk_add_f32 v[134:135], v[134:135], v[142:143]
  v_pk_add_f32 v[128:129], v[128:129], v[132:133]
  v_pk_add_f32 v[130:131], v[130:131], v[134:135]
  s_nop 0
  v_add_f32_dpp v132, v128, v128 row_ror:8 row_mask:0xf bank_mask:0x3
  v_add_f32_dpp v132, v130, v130 row_ror:8 row_mask:0xf bank_mask:0xc
  v_add_f32_dpp v133, v129, v129 row_ror:8 row_mask:0xf bank_mask:0x3
  v_add_f32_dpp v133, v131, v131 row_ror:8 row_mask:0xf bank_mask:0xc
  v_add_f32_dpp v134, v132, v132 row_ror:12 row_mask:0xf bank_mask:0x5
  s_nop 0
  v_add_f32_dpp v135, v133, v133 row_ror:12 row_mask:0xf bank_mask:0x5
  v_add_f32_dpp v134, v132, v132 row_ror:4 row_mask:0xf bank_mask:0xa
  v_add_f32_dpp v135, v133, v133 row_ror:4 row_mask:0xf bank_mask:0xa
  v_cvt_pk_bf16_f32 v128, v134, v135
  s_nop 1
  v_mov_b32_dpp v136, v128 quad_perm:[0,0,0,0] row_mask:0xf bank_mask:0xf
  v_mov_b32_dpp v137, v128 quad_perm:[1,1,1,1] row_mask:0xf bank_mask:0xf
  v_mov_b32_dpp v138, v128 quad_perm:[2,2,2,2] row_mask:0xf bank_mask:0xf
  v_mov_b32_dpp v139, v128 quad_perm:[3,3,3,3] row_mask:0xf bank_mask:0xf
  v_dot2_f32_bf16 v140, v48, v136, 0
  v_dot2_f32_bf16 v141, v49, v136, 0
  v_dot2_f32_bf16 v142, v50, v136, 0
  v_dot2_f32_bf16 v143, v51, v136, 0
  v_dot2_f32_bf16 v144, v52, v136, 0
  v_dot2_f32_bf16 v145, v53, v136, 0
  v_dot2_f32_bf16 v146, v54, v136, 0
  v_dot2_f32_bf16 v147, v55, v136, 0
  v_dot2_f32_bf16 v140, v56, v137, v140
  v_dot2_f32_bf16 v141, v57, v137, v141
  v_dot2_f32_bf16 v142, v58, v137, v142
  v_dot2_f32_bf16 v143, v59, v137, v143
  v_dot2_f32_bf16 v144, v60, v137, v144
  v_dot2_f32_bf16 v145, v61, v137, v145
  v_dot2_f32_bf16 v146, v62, v137, v146
  v_dot2_f32_bf16 v147, v63, v137, v147
  v_dot2_f32_bf16 v140, v64, v138, v140
  v_dot2_f32_bf16 v141, v65, v138, v141
  v_dot2_f32_bf16 v142, v66, v138, v142
  v_dot2_f32_bf16 v143, v67, v138, v143
  v_dot2_f32_bf16 v144, v68, v138, v144
  v_dot2_f32_bf16 v145, v69, v138, v145
  v_dot2_f32_bf16 v146, v70, v138, v146
  v_dot2_f32_bf16 v147, v71, v138, v147
  v_dot2_f32_bf16 v140, v72, v139, v140
  v_dot2_f32_bf16 v141, v73, v139, v141
  v_dot2_f32_bf16 v142, v74, v139, v142
  v_dot2_f32_bf16 v143, v75, v139, v143
  v_dot2_f32_bf16 v144, v76, v139, v144
  v_dot2_f32_bf16 v145, v77, v139, v145
  v_dot2_f32_bf16 v146, v78, v139, v146
  v_dot2_f32_bf16 v147, v79, v139, v147
  v_permlane32_swap_b32 v140, v144
  v_permlane32_swap_b32 v141, v145
  v_permlane32_swap_b32 v142, v146
  v_permlane32_swap_b32 v143, v147
  v_add_f32 v140, v140, v144
  v_add_f32 v141, v141, v145
  v_add_f32 v142, v142, v146
  v_add_f32 v143, v143, v147
  s_nop 0
  v_permlane16_swap_b32 v140, v142
  v_permlane16_swap_b32 v141, v143
  v_add_f32 v140, v140, v142
  v_add_f32 v141, v141, v143
  s_nop 0
  v_add_f32_dpp v132, v140, v140 row_ror:8 row_mask:0xf bank_mask:0x3
  v_add_f32_dpp v132, v141, v141 row_ror:8 row_mask:0xf bank_mask:0xc
  ds_write_b32 v123, v132 offset:10240
  s_mov_b64 exec, -1
  s_waitcnt lgkmcnt(0)
  s_barrier
  s_cmp_lg_u32 s3, 0
  s_cbranch_scc1 La_55
  s_mov_b64 exec, 0xffff
  ds_read_b128 v[80:83], v2 offset:10240
  ds_read_b128 v[84:87], v2 offset:10496
  ds_read_b128 v[88:91], v2 offset:10752
  ds_read_b128 v[92:95], v2 offset:11008
  s_waitcnt lgkmcnt(2)
  v_pk_add_f32 v[80:81], v[80:81], v[84:85]
  v_pk_add_f32 v[82:83], v[82:83], v[86:87]
  s_waitcnt lgkmcnt(0)
  v_pk_add_f32 v[88:89], v[88:89], v[92:93]
  v_pk_add_f32 v[90:91], v[90:91], v[94:95]
  v_pk_add_f32 v[80:81], v[80:81], v[88:89]
  v_pk_add_f32 v[82:83], v[82:83], v[90:91]
  buffer_store_dwordx4 v[80:83], v2, s[40:43], s80 offen sc1
  s_mov_b64 exec, -1
La_55:
  s_cmp_gt_u32 s3, 1
  s_cbranch_scc1 Lc_56
  buffer_store_dwordx4 v[112:115], v2, s[40:43], s24 offen sc1
Lc_56:
L_s3:
  s_cmp_eq_u32 s5, 0
  s_cbranch_scc1 L_fin
  v_lshrrev_b32 v122, 5, v0
  v_lshlrev_b32 v122, 11, v122
  v_and_b32 v1, 31, v0
  v_lshl_add_u32 v122, v1, 4, v122
  s_lshl_b32 s81, s3, 9
  s_add_u32 s10, s81, 1048576
  s_add_u32 s11, s81, 1052672
  s_add_u32 s12, s81, 1056768
  s_add_u32 s13, s81, 1060864
  s_add_u32 s14, s81, 1064960
  s_add_u32 s15, s81, 1069056
  s_add_u32 s16, s81, 1073152
  s_add_u32 s17, s81, 1077248
  buffer_load_dwordx4 v[128:131], v122, s[40:43], s10 offen sc1
  buffer_load_dwordx4 v[132:135], v122, s[40:43], s11 offen sc1
  buffer_load_dwordx4 v[136:139], v122, s[40:43], s12 offen sc1
  buffer_load_dwordx4 v[140:143], v122, s[40:43], s13 offen sc1
  buffer_load_dwordx4 v[144:147], v122, s[40:43], s14 offen sc1
  buffer_load_dwordx4 v[148:151], v122, s[40:43], s15 offen sc1
  buffer_load_dwordx4 v[152:155], v122, s[40:43], s16 offen sc1
  buffer_load_dwordx4 v[156:159], v122, s[40:43], s17 offen sc1
  s_waitcnt vmcnt(16)
  v_accvgpr_read_b32 v96, a128
  v_accvgpr_read_b32 v97, a129
  v_accvgpr_read_b32 v98, a130
  v_accvgpr_read_b32 v99, a131
  v_accvgpr_read_b32 v100, a132
  v_accvgpr_read_b32 v101, a133
  v_accvgpr_read_b32 v102, a134
  v_accvgpr_read_b32 v103, a135
  v_accvgpr_read_b32 v104, a136
  v_accvgpr_read_b32 v105, a137
  v_accvgpr_read_b32 v106, a138
  v_accvgpr_read_b32 v107, a139
  v_accvgpr_read_b32 v108, a140
  v_accvgpr_read_b32 v109, a141
  v_accvgpr_read_b32 v110, a142
  v_accvgpr_read_b32 v111, a143
  v_perm_b32 v208, v100, v96, s74
  v_perm_b32 v209, v100, v96, s75
  v_perm_b32 v210, v101, v97, s74
  v_perm_b32 v211, v101, v97, s75
  v_perm_b32 v212, v102, v98, s74
  v_perm_b32 v213, v102, v98, s75
  v_perm_b32 v214, v103, v99, s74
  v_perm_b32 v215, v103, v99, s75
  v_perm_b32 v216, v108, v104, s74
  v_perm_b32 v217, v108, v104, s75
  v_perm_b32 v218, v109, v105, s74
  v_perm_b32 v219, v109, v105, s75
  v_perm_b32 v220, v110, v106, s74
  v_perm_b32 v221, v110, v106, s75
  v_perm_b32 v222, v111, v107, s74
  v_perm_b32 v223, v111, v107, s75
  s_waitcnt vmcnt(12)
  v_accvgpr_read_b32 v96, a144
  v_accvgpr_read_b32 v97, a145
  v_accvgpr_read_b32 v98, a146
  v_accvgpr_read_b32 v99, a147
  v_accvgpr_read_b32 v100, a148
  v_accvgpr_read_b32 v101, a149
  v_accvgpr_read_b32 v102, a150
  v_accvgpr_read_b32 v103, a151
  v_accvgpr_read_b32 v104, a152
  v_accvgpr_read_b32 v105, a153
  v_accvgpr_read_b32 v106, a154
  v_accvgpr_read_b32 v107, a155
  v_accvgpr_read_b32 v108, a156
  v_accvgpr_read_b32 v109, a157
  v_accvgpr_read_b32 v110, a158
  v_accvgpr_read_b32 v111, a159
  v_perm_b32 v224, v100, v96, s74
  v_perm_b32 v225, v100, v96, s75
  v_perm_b32 v226, v101, v97, s74
  v_perm_b32 v227, v101, v97, s75
  v_perm_b32 v228, v102, v98, s74
  v_perm_b32 v229, v102, v98, s75
  v_perm_b32 v230, v103, v99, s74
  v_perm_b32 v231, v103, v99, s75
  v_perm_b32 v232, v108, v104, s74
  v_perm_b32 v233, v108, v104, s75
  v_perm_b32 v234, v109, v105, s74
  v_perm_b32 v235, v109, v105, s75
  v_perm_b32 v236, v110, v106, s74
  v_perm_b32 v237, v110, v106, s75
  v_perm_b32 v238, v111, v107, s74
  v_perm_b32 v239, v111, v107, s75
  s_waitcnt vmcnt(8)
  v_accvgpr_read_b32 v96, a160
  v_accvgpr_read_b32 v97, a161
  v_accvgpr_read_b32 v98, a162
  v_accvgpr_read_b32 v99, a163
  v_accvgpr_read_b32 v100, a164
  v_accvgpr_read_b32 v101, a165
  v_accvgpr_read_b32 v102, a166
  v_accvgpr_read_b32 v103, a167
  v_accvgpr_read_b32 v104, a168
  v_accvgpr_read_b32 v105, a169
  v_accvgpr_read_b32 v106, a170
  v_accvgpr_read_b32 v107, a171
  v_accvgpr_read_b32 v108, a172
  v_accvgpr_read_b32 v109, a173
  v_accvgpr_read_b32 v110, a174
  v_accvgpr_read_b32 v111, a175
  v_perm_b32 v240, v100, v96, s74
  v_perm_b32 v241, v100, v96, s75
  v_perm_b32 v242, v101, v97, s74
  v_perm_b32 v243, v101, v97, s75
  v_perm_b32 v244, v102, v98, s74
  v_perm_b32 v245, v102, v98, s75
  v_perm_b32 v246, v103, v99, s74
  v_perm_b32 v247, v103, v99, s75
  v_perm_b32 v248, v108, v104, s74
  v_perm_b32 v249, v108, v104, s75
  v_perm_b32 v250, v109, v105, s74
  v_perm_b32 v251, v109, v105, s75
  v_perm_b32 v252, v110, v106, s74
  v_perm_b32 v253, v110, v106, s75
  v_perm_b32 v254, v111, v107, s74
  v_perm_b32 v255, v111, v107, s75
  v_lshlrev_b32 v124, 16, v4
  v_and_b32 v125, 0xffff0000, v4
  v_lshlrev_b32 v126, 3, v1
  v_lshrrev_b32 v1, 5, v0
  v_lshl_add_u32 v126, v1, 2, v126
  s_lshl_b32 s81, s3, 8
  v_add_u32 v126, s81, v126
  v_lshrrev_b32 v127, 1, v0
  v_lshlrev_b32 v127, 3, v127
  v_add_u32 v127, s81, v127
  v_lshrrev_b32 v123, 5, v0
  v_lshlrev_b32 v123, 8, v123
  v_and_b32 v1, 1, v0
  v_lshl_add_u32 v123, v1, 7, v123
  v_bfe_u32 v1, v0, 4, 1
  v_lshl_add_u32 v123, v1, 6, v123
  s_lshl_b32 s81, s3, 2
  v_add_u32 v123, s81, v123
  s_waitcnt vmcnt(0)
  v_max3_u32 v120, v128, v129, v130
  v_max_u32 v120, v120, v131
  v_cmp_eq_u32 s[86:87], -1, v120
  v_max3_u32 v121, v132, v133, v134
  v_max_u32 v121, v121, v135
  v_cmp_eq_u32 s[88:89], -1, v121
  v_max3_u32 v120, v136, v137, v138
  v_max_u32 v120, v120, v139
  v_cmp_eq_u32 s[90:91], -1, v120
  v_max3_u32 v121, v140, v141, v142
  v_max_u32 v121, v121, v143
  v_cmp_eq_u32 s[92:93], -1, v121
  v_max3_u32 v120, v144, v145, v146
  v_max_u32 v120, v120, v147
  v_cmp_eq_u32 s[94:95], -1, v120
  v_max3_u32 v121, v148, v149, v150
  v_max_u32 v121, v121, v151
  v_cmp_eq_u32 s[96:97], -1, v121
  v_max3_u32 v120, v152, v153, v154
  v_max_u32 v120, v120, v155
  v_cmp_eq_u32 s[98:99], -1, v120
  v_max3_u32 v121, v156, v157, v158
  v_max_u32 v121, v121, v159
  v_cmp_eq_u32 s[100:101], -1, v121
  s_or_b64 s[84:85], s[86:87], s[88:89]
  s_or_b64 s[84:85], s[84:85], s[90:91]
  s_or_b64 s[84:85], s[84:85], s[92:93]
  s_or_b64 s[84:85], s[84:85], s[94:95]
  s_or_b64 s[84:85], s[84:85], s[96:97]
  s_or_b64 s[84:85], s[84:85], s[98:99]
  s_or_b64 s[84:85], s[84:85], s[100:101]
  s_cmp_eq_u64 s[84:85], 0
  s_cbranch_scc1 Lpd_57
  s_mov_b32 s78, 200000
Lpr_58:
  s_cmp_eq_u64 s[86:87], 0
  s_cbranch_scc1 Lps_59
  s_mov_b64 exec, s[86:87]
  buffer_load_dwordx4 v[128:131], v122, s[40:43], s10 offen sc1
Lps_59:
  s_cmp_eq_u64 s[88:89], 0
  s_cbranch_scc1 Lps_60
  s_mov_b64 exec, s[88:89]
  buffer_load_dwordx4 v[132:135], v122, s[40:43], s11 offen sc1
Lps_60:
  s_cmp_eq_u64 s[90:91], 0
  s_cbranch_scc1 Lps_61
  s_mov_b64 exec, s[90:91]
  buffer_load_dwordx4 v[136:139], v122, s[40:43], s12 offen sc1
Lps_61:
  s_cmp_eq_u64 s[92:93], 0
  s_cbranch_scc1 Lps_62
  s_mov_b64 exec, s[92:93]
  buffer_load_dwordx4 v[140:143], v122, s[40:43], s13 offen sc1
Lps_62:
  s_cmp_eq_u64 s[94:95], 0
  s_cbranch_scc1 Lps_63
  s_mov_b64 exec, s[94:95]
  buffer_load_dwordx4 v[144:147], v122, s[40:43], s14 offen sc1
Lps_63:
  s_cmp_eq_u64 s[96:97], 0
  s_cbranch_scc1 Lps_64
  s_mov_b64 exec, s[96:97]
  buffer_load_dwordx4 v[148:151], v122, s[40:43], s15 offen sc1
Lps_64:
  s_cmp_eq_u64 s[98:99], 0
  s_cbranch_scc1 Lps_65
  s_mov_b64 exec, s[98:99]
  buffer_load_dwordx4 v[152:155], v122, s[40:43], s16 offen sc1
Lps_65:
  s_cmp_eq_u64 s[100:101], 0
  s_cbranch_scc1 Lps_66
  s_mov_b64 exec, s[100:101]
  buffer_load_dwordx4 v[156:159], v122, s[40:43], s17 offen sc1
Lps_66:
  s_mov_b64 exec, -1
  s_waitcnt vmcnt(0)
  s_cmp_eq_u64 s[86:87], 0
  s_cbranch_scc1 Lpc_67
  v_max3_u32 v120, v128, v129, v130
  v_max_u32 v120, v120, v131
  v_cmp_eq_u32 s[86:87], -1, v120
Lpc_67:
  s_cmp_eq_u64 s[88:89], 0
  s_cbranch_scc1 Lpc_68
  v_max3_u32 v121, v132, v133, v134
  v_max_u32 v121, v121, v135
  v_cmp_eq_u32 s[88:89], -1, v121
Lpc_68:
  s_cmp_eq_u64 s[90:91], 0
  s_cbranch_scc1 Lpc_69
  v_max3_u32 v120, v136, v137, v138
  v_max_u32 v120, v120, v139
  v_cmp_eq_u32 s[90:91], -1, v120
Lpc_69:
  s_cmp_eq_u64 s[92:93], 0
  s_cbranch_scc1 Lpc_70
  v_max3_u32 v121, v140, v141, v142
  v_max_u32 v121, v121, v143
  v_cmp_eq_u32 s[92:93], -1, v121
Lpc_70:
  s_cmp_eq_u64 s[94:95], 0
  s_cbranch_scc1 Lpc_71
  v_max3_u32 v120, v144, v145, v146
  v_max_u32 v120, v120, v147
  v_cmp_eq_u32 s[94:95], -1, v120
Lpc_71:
  s_cmp_eq_u64 s[96:97], 0
  s_cbranch_scc1 Lpc_72
  v_max3_u32 v121, v148, v149, v150
  v_max_u32 v121, v121, v151
  v_cmp_eq_u32 s[96:97], -1, v121
Lpc_72:
  s_cmp_eq_u64 s[98:99], 0
  s_cbranch_scc1 Lpc_73
  v_max3_u32 v120, v152, v153, v154
  v_max_u32 v120, v120, v155
  v_cmp_eq_u32 s[98:99], -1, v120
Lpc_73:
  s_cmp_eq_u64 s[100:101], 0
  s_cbranch_scc1 Lpc_74
  v_max3_u32 v121, v156, v157, v158
  v_max_u32 v121, v121, v159
  v_cmp_eq_u32 s[100:101], -1, v121
Lpc_74:
  s_or_b64 s[84:85], s[86:87], s[88:89]
  s_or_b64 s[84:85], s[84:85], s[90:91]
  s_or_b64 s[84:85], s[84:85], s[92:93]
  s_or_b64 s[84:85], s[84:85], s[94:95]
  s_or_b64 s[84:85], s[84:85], s[96:97]
  s_or_b64 s[84:85], s[84:85], s[98:99]
  s_or_b64 s[84:85], s[84:85], s[100:101]
  s_cmp_eq_u64 s[84:85], 0
  s_cbranch_scc1 Lpd_57
  s_sub_u32 s78, s78, 1
  s_cmp_lg_u32 s78, 0
  s_cbranch_scc1 Lpr_58
Lpd_57:
  s_cmp_gt_u32 s3, 1
  s_cbranch_scc1 Lc_75
  buffer_store_dwordx4 v[112:115], v2, s[40:43], s24 offen sc1
Lc_75:
  v_pk_add_f32 v[128:129], v[128:129], v[144:145]
  v_pk_add_f32 v[130:131], v[130:131], v[146:147]
  v_pk_add_f32 v[132:133], v[132:133], v[148:149]
  v_pk_add_f32 v[134:135], v[134:135], v[150:151]
  v_pk_add_f32 v[136:137], v[136:137], v[152:153]
  v_pk_add_f32 v[138:139], v[138:139], v[154:155]
  v_pk_add_f32 v[140:141], v[140:141], v[156:157]
  v_pk_add_f32 v[142:143], v[142:143], v[158:159]
  v_pk_add_f32 v[128:129], v[128:129], v[136:137]
  v_pk_add_f32 v[130:131], v[130:131], v[138:139]
  v_pk_add_f32 v[132:133], v[132:133], v[140:141]
  v_pk_add_f32 v[134:135], v[134:135], v[142:143]
  v_pk_add_f32 v[128:129], v[128:129], v[132:133]
  v_pk_add_f32 v[130:131], v[130:131], v[134:135]
  s_nop 1
  v_permlane32_swap_b32 v128, v130
  v_permlane32_swap_b32 v129, v131
  v_add_f32 v128, v128, v130
  v_add_f32 v129, v129, v131
  v_cvt_pk_bf16_f32 v128, 0, v128
  v_cvt_pk_bf16_f32 v129, 0, v129
  v_add_f32 v128, v128, v124
  v_add_f32 v129, v129, v125
  v_cvt_pk_bf16_f32 v134, v128, v129
  v_lshlrev_b32 v128, 16, v134
  v_and_b32 v129, 0xffff0000, v134
  ds_write_b32 v126, v134 offset:11264
  v_add_f32 v132, v128, v129
  v_mul_f32 v133, v128, v128
  v_fmac_f32 v133, v129, v129
  v_add_f32_dpp v132, v132, v132 row_ror:8 row_mask:0xf bank_mask:0xf
  s_nop 0
  v_add_f32_dpp v133, v133, v133 row_ror:8 row_mask:0xf bank_mask:0xf
  v_add_f32_dpp v132, v132, v132 row_ror:4 row_mask:0xf bank_mask:0xf
  s_nop 0
  v_add_f32_dpp v133, v133, v133 row_ror:4 row_mask:0xf bank_mask:0xf
  v_add_f32_dpp v132, v132, v132 row_ror:2 row_mask:0xf bank_mask:0xf
  s_nop 0
  v_add_f32_dpp v133, v133, v133 row_ror:2 row_mask:0xf bank_mask:0xf
  v_add_f32_dpp v132, v132, v132 row_ror:1 row_mask:0xf bank_mask:0xf
  s_nop 0
  v_add_f32_dpp v133, v133, v133 row_ror:1 row_mask:0xf bank_mask:0xf
  v_add_f32_dpp v132, v132, v132 row_bcast:15 row_mask:0xa bank_mask:0xf
  s_nop 0
  v_add_f32_dpp v133, v133, v133 row_bcast:15 row_mask:0xa bank_mask:0xf
  v_add_f32_dpp v132, v132, v132 row_bcast:31 row_mask:0xc bank_mask:0xf
  s_nop 0
  v_add_f32_dpp v133, v133, v133 row_bcast:31 row_mask:0xc bank_mask:0xf
  s_lshl_b32 s81, s3, 3
  v_mov_b32 v1, s81
  v_mov_b32 v135, 0
  s_mov_b32 exec_lo, 0
  s_mov_b32 exec_hi, 0x80000000
  ds_write_b64 v1, v[132:133] offset:13952
  s_mov_b64 exec, -1
  s_waitcnt lgkmcnt(0)
  s_barrier
  ds_read_b128 v[136:139], v135 offset:13952
  ds_read_b128 v[140:143], v135 offset:13968
  s_waitcnt lgkmcnt(0)
  v_pk_add_f32 v[136:137], v[136:137], v[138:139]
  v_pk_add_f32 v[140:141], v[140:141], v[142:143]
  v_pk_add_f32 v[136:137], v[136:137], v[140:141]
  v_mul_f32 v136, 0x3b000000, v136
  v_mul_f32 v137, 0x3b000000, v137
  v_fma_f32 v137, -v136, v136, v137
  v_cvt_pk_bf16_f32 v138, 0, v136
  v_cvt_pk_bf16_f32 v139, 0, v137
  v_add_f32 v139, 0x3727c5ac, v139
  v_cvt_pk_bf16_f32 v139, 0, v139
  v_sqrt_f32 v139, v139
  s_nop 0
  v_cvt_pk_bf16_f32 v139, 0, v139
  v_rcp_f32 v139, v139
  v_sub_f32 v128, v128, v138
  v_sub_f32 v129, v129, v138
  v_cvt_pk_bf16_f32 v128, 0, v128
  v_cvt_pk_bf16_f32 v129, 0, v129
  v_mul_f32 v128, v128, v139
  v_mul_f32 v129, v129, v139
  v_cvt_pk_bf16_f32 v134, v128, v129
  ds_write_b32 v126, v134 offset:12288
  ds_read_b64 v[140:141], v127 offset:12288
  s_waitcnt lgkmcnt(0)
  v_dot2_f32_bf16 v144, v208, v140, 0
  v_dot2_f32_bf16 v145, v209, v140, 0
  v_dot2_f32_bf16 v146, v210, v140, 0
  v_dot2_f32_bf16 v147, v211, v140, 0
  v_dot2_f32_bf16 v148, v212, v140, 0
  v_dot2_f32_bf16 v149, v213, v140, 0
  v_dot2_f32_bf16 v150, v214, v140, 0
  v_dot2_f32_bf16 v151, v215, v140, 0
  v_dot2_f32_bf16 v152, v224, v140, 0
  v_dot2_f32_bf16 v153, v225, v140, 0
  v_dot2_f32_bf16 v154, v226, v140, 0
  v_dot2_f32_bf16 v155, v227, v140, 0
  v_dot2_f32_bf16 v156, v228, v140, 0
  v_dot2_f32_bf16 v157, v229, v140, 0
  v_dot2_f32_bf16 v158, v230, v140, 0
  v_dot2_f32_bf16 v159, v231, v140, 0
  v_dot2_f32_bf16 v144, v216, v141, v144
  v_dot2_f32_bf16 v145, v217, v141, v145
  v_dot2_f32_bf16 v146, v218, v141, v146
  v_dot2_f32_bf16 v147, v219, v141, v147
  v_dot2_f32_bf16 v148, v220, v141, v148
  v_dot2_f32_bf16 v149, v221, v141, v149
  v_dot2_f32_bf16 v150, v222, v141, v150
  v_dot2_f32_bf16 v151, v223, v141, v151
  v_dot2_f32_bf16 v152, v232, v141, v152
  v_dot2_f32_bf16 v153, v233, v141, v153
  v_dot2_f32_bf16 v154, v234, v141, v154
  v_dot2_f32_bf16 v155, v235, v141, v155
  v_dot2_f32_bf16 v156, v236, v141, v156
  v_dot2_f32_bf16 v157, v237, v141, v157
  v_dot2_f32_bf16 v158, v238, v141, v158
  v_dot2_f32_bf16 v159, v239, v141, v159
  v_permlane32_swap_b32 v144, v152
  v_permlane32_swap_b32 v145, v153
  v_permlane32_swap_b32 v146, v154
  v_permlane32_swap_b32 v147, v155
  v_permlane32_swap_b32 v148, v156
  v_permlane32_swap_b32 v149, v157
  v_permlane32_swap_b32 v150, v158
  v_permlane32_swap_b32 v151, v159
  v_add_f32 v144, v144, v152
  v_add_f32 v145, v145, v153
  v_add_f32 v146, v146, v154
  v_add_f32 v147, v147, v155
  v_add_f32 v148, v148, v156
  v_add_f32 v149, v149, v157
  v_add_f32 v150, v150, v158
  v_add_f32 v151, v151, v159
  v_permlane16_swap_b32 v144, v148
  v_permlane16_swap_b32 v145, v149
  v_permlane16_swap_b32 v146, v150
  v_permlane16_swap_b32 v147, v151
  v_add_f32 v144, v144, v148
  v_add_f32 v145, v145, v149
  v_add_f32 v146, v146, v150
  v_add_f32 v147, v147, v151
  v_add_f32_dpp v144, v144, v144 row_ror:4 row_mask:0xf bank_mask:0xf
  v_add_f32_dpp v145, v145, v145 row_ror:4 row_mask:0xf bank_mask:0xf
  v_add_f32_dpp v146, v146, v146 row_ror:4 row_mask:0xf bank_mask:0xf
  v_add_f32_dpp v147, v147, v147 row_ror:4 row_mask:0xf bank_mask:0xf
  v_add_f32_dpp v144, v144, v144 row_ror:8 row_mask:0xf bank_mask:0xf
  v_add_f32_dpp v145, v145, v145 row_ror:8 row_mask:0xf bank_mask:0xf
  v_add_f32_dpp v146, v146, v146 row_ror:8 row_mask:0xf bank_mask:0xf
  v_add_f32_dpp v147, v147, v147 row_ror:8 row_mask:0xf bank_mask:0xf
  v_add_f32_dpp v144, v144, v144 quad_perm:[2,3,0,1] row_mask:0xf bank_mask:0xf
  v_add_f32_dpp v145, v145, v145 quad_perm:[2,3,0,1] row_mask:0xf bank_mask:0xf
  v_add_f32_dpp v146, v146, v146 quad_perm:[2,3,0,1] row_mask:0xf bank_mask:0xf
  v_add_f32_dpp v147, v147, v147 quad_perm:[2,3,0,1] row_mask:0xf bank_mask:0xf
  s_mov_b32 exec_lo, 0x00030003
  s_mov_b32 exec_hi, 0x00030003
  ds_write_b32 v123, v144 offset:13312
  ds_write_b32 v123, v145 offset:13328
  ds_write_b32 v123, v146 offset:13344
  ds_write_b32 v123, v147 offset:13360
  s_mov_b64 exec, -1
  v_and_b32 v1, 0xf0, v2
  v_lshrrev_b32 v123, 4, v0
  v_lshlrev_b32 v123, 7, v123
  v_and_b32 v124, 3, v0
  v_lshl_add_u32 v123, v124, 5, v123
  v_bfe_u32 v124, v0, 2, 2
  v_lshl_add_u32 v123, v124, 3, v123
  s_lshl_b32 s82, s4, 11
  s_lshl_b32 s81, s3, 9
  s_add_u32 s82, s82, s81
  s_add_u32 s82, s82, 1114112
  s_waitcnt lgkmcnt(0)
  s_barrier
  ds_read_b128 v[136:139], v1 offset:13312
  ds_read_b128 v[140:143], v1 offset:13568
  s_waitcnt lgkmcnt(0)
  v_pk_add_f32 v[136:137], v[136:137], v[138:139]
  v_pk_add_f32 v[140:141], v[140:141], v[142:143]
  v_add_f32 v136, v136, v137
  v_add_f32 v140, v140, v141
  v_cvt_pk_bf16_f32 v136, 0, v136
  v_cvt_pk_bf16_f32 v140, 0, v140
  v_max_f32 v136, 0, v136
  v_mul_f32 v136, v136, v140
  v_cvt_pk_bf16_f32 v137, v136, 0
  v_cvt_pk_bf16_f32 v136, 0, v136
  s_nop 0
  v_mov_b32_dpp v140, v137 quad_perm:[0,0,0,0] row_mask:0xf bank_mask:0xf
  v_mov_b32_dpp v141, v137 quad_perm:[2,2,2,2] row_mask:0xf bank_mask:0xf
  v_or_b32_dpp v140, v136, v140 quad_perm:[1,1,1,1] row_mask:0xf bank_mask:0xf
  v_or_b32_dpp v141, v136, v141 quad_perm:[3,3,3,3] row_mask:0xf bank_mask:0xf
  v_dot2_f32_bf16 v144, v240, v140, 0
  v_dot2_f32_bf16 v145, v241, v140, 0
  v_dot2_f32_bf16 v146, v242, v140, 0
  v_dot2_f32_bf16 v147, v243, v140, 0
  v_dot2_f32_bf16 v148, v244, v140, 0
  v_dot2_f32_bf16 v149, v245, v140, 0
  v_dot2_f32_bf16 v150, v246, v140, 0
  v_dot2_f32_bf16 v151, v247, v140, 0
  v_dot2_f32_bf16 v144, v248, v141, v144
  v_dot2_f32_bf16 v145, v249, v141, v145
  v_dot2_f32_bf16 v146, v250, v141, v146
  v_dot2_f32_bf16 v147, v251, v141, v147
  v_dot2_f32_bf16 v148, v252, v141, v148
  v_dot2_f32_bf16 v149, v253, v141, v149
  v_dot2_f32_bf16 v150, v254, v141, v150
  v_dot2_f32_bf16 v151, v255, v141, v151
  v_add_f32_dpp v152, v144, v144 row_ror:8 row_mask:0xf bank_mask:0x3
  v_add_f32_dpp v152, v148, v148 row_ror:8 row_mask:0xf bank_mask:0xc
  v_add_f32_dpp v153, v145, v145 row_ror:8 row_mask:0xf bank_mask:0x3
  v_add_f32_dpp v153, v149, v149 row_ror:8 row_mask:0xf bank_mask:0xc
  v_add_f32_dpp v154, v146, v146 row_ror:8 row_mask:0xf bank_mask:0x3
  v_add_f32_dpp v154, v150, v150 row_ror:8 row_mask:0xf bank_mask:0xc
  v_add_f32_dpp v155, v147, v147 row_ror:8 row_mask:0xf bank_mask:0x3
  v_add_f32_dpp v155, v151, v151 row_ror:8 row_mask:0xf bank_mask:0xc
  v_add_f32_dpp v156, v152, v152 row_ror:12 row_mask:0xf bank_mask:0x5
  v_add_f32_dpp v156, v154, v154 row_ror:4 row_mask:0xf bank_mask:0xa
  v_add_f32_dpp v157, v153, v153 row_ror:12 row_mask:0xf bank_mask:0x5
  v_add_f32_dpp v157, v155, v155 row_ror:4 row_mask:0xf bank_mask:0xa
  buffer_store_dwordx2 v[156:157], v123, s[40:43], s82 offen sc1
  s_lshl_b32 s9, s3, 8
  s_add_u32 s9, s9, s4
  s_cmp_ge_u32 s9, 32
  s_cbranch_scc1 L_fin
  v_lshrrev_b32 v122, 2, v0
  v_lshlrev_b32 v122, 11, v122
  v_and_b32 v1, 3, v0
  v_lshl_add_u32 v122, v1, 4, v122
  s_lshl_b32 s81, s4, 6
  s_add_u32 s10, s81, 1114112
  s_add_u32 s11, s81, 1146880
  s_add_u32 s12, s81, 1179648
  s_add_u32 s13, s81, 1212416
  s_add_u32 s14, s81, 1245184
  s_add_u32 s15, s81, 1277952
  s_add_u32 s16, s81, 1310720
  buffer_load_dwordx4 v[128:131], v122, s[40:43], s10 offen sc1
  buffer_load_dwordx4 v[132:135], v122, s[40:43], s11 offen sc1
  buffer_load_dwordx4 v[136:139], v122, s[40:43], s12 offen sc1
  buffer_load_dwordx4 v[140:143], v122, s[40:43], s13 offen sc1
  buffer_load_dwordx4 v[144:147], v122, s[40:43], s14 offen sc1
  buffer_load_dwordx4 v[148:151], v122, s[40:43], s15 offen sc1
  buffer_load_dwordx4 v[152:155], v122, s[40:43], s16 offen sc1
  v_lshlrev_b32 v124, 3, v1
  v_lshrrev_b32 v125, 5, v0
  v_lshl_add_u32 v124, v125, 2, v124
  v_bfe_u32 v125, v0, 4, 1
  v_lshl_add_u32 v124, v125, 1, v124
  s_lshl_b32 s81, s4, 5
  v_add_u32 v124, s81, v124
  ds_read_u16 v125, v124 offset:11264
  v_mov_b32 v126, s30
  s_waitcnt lgkmcnt(0)
  v_lshlrev_b32 v125, 16, v125
  s_waitcnt vmcnt(0)
  v_max3_u32 v120, v128, v129, v130
  v_max_u32 v120, v120, v131
  v_cmp_eq_u32 s[86:87], -1, v120
  v_max3_u32 v121, v132, v133, v134
  v_max_u32 v121, v121, v135
  v_cmp_eq_u32 s[88:89], -1, v121
  v_max3_u32 v120, v136, v137, v138
  v_max_u32 v120, v120, v139
  v_cmp_eq_u32 s[90:91], -1, v120
  v_max3_u32 v121, v140, v141, v142
  v_max_u32 v121, v121, v143
  v_cmp_eq_u32 s[92:93], -1, v121
  v_max3_u32 v120, v144, v145, v146
  v_max_u32 v120, v120, v147
  v_cmp_eq_u32 s[94:95], -1, v120
  v_max3_u32 v121, v148, v149, v150
  v_max_u32 v121, v121, v151
  v_cmp_eq_u32 s[96:97], -1, v121
  v_max3_u32 v120, v152, v153, v154
  v_max_u32 v120, v120, v155
  v_cmp_eq_u32 s[98:99], -1, v120
  s_or_b64 s[84:85], s[86:87], s[88:89]
  s_or_b64 s[84:85], s[84:85], s[90:91]
  s_or_b64 s[84:85], s[84:85], s[92:93]
  s_or_b64 s[84:85], s[84:85], s[94:95]
  s_or_b64 s[84:85], s[84:85], s[96:97]
  s_or_b64 s[84:85], s[84:85], s[98:99]
  s_cmp_eq_u64 s[84:85], 0
  s_cbranch_scc1 Lpd_76
  s_mov_b32 s78, 200000
Lpr_77:
  s_cmp_eq_u64 s[86:87], 0
  s_cbranch_scc1 Lps_78
  s_mov_b64 exec, s[86:87]
  buffer_load_dwordx4 v[128:131], v122, s[40:43], s10 offen sc1
Lps_78:
  s_cmp_eq_u64 s[88:89], 0
  s_cbranch_scc1 Lps_79
  s_mov_b64 exec, s[88:89]
  buffer_load_dwordx4 v[132:135], v122, s[40:43], s11 offen sc1
Lps_79:
  s_cmp_eq_u64 s[90:91], 0
  s_cbranch_scc1 Lps_80
  s_mov_b64 exec, s[90:91]
  buffer_load_dwordx4 v[136:139], v122, s[40:43], s12 offen sc1
Lps_80:
  s_cmp_eq_u64 s[92:93], 0
  s_cbranch_scc1 Lps_81
  s_mov_b64 exec, s[92:93]
  buffer_load_dwordx4 v[140:143], v122, s[40:43], s13 offen sc1
Lps_81:
  s_cmp_eq_u64 s[94:95], 0
  s_cbranch_scc1 Lps_82
  s_mov_b64 exec, s[94:95]
  buffer_load_dwordx4 v[144:147], v122, s[40:43], s14 offen sc1
Lps_82:
  s_cmp_eq_u64 s[96:97], 0
  s_cbranch_scc1 Lps_83
  s_mov_b64 exec, s[96:97]
  buffer_load_dwordx4 v[148:151], v122, s[40:43], s15 offen sc1
Lps_83:
  s_cmp_eq_u64 s[98:99], 0
  s_cbranch_scc1 Lps_84
  s_mov_b64 exec, s[98:99]
  buffer_load_dwordx4 v[152:155], v122, s[40:43], s16 offen sc1
Lps_84:
  s_mov_b64 exec, -1
  s_waitcnt vmcnt(0)
  s_cmp_eq_u64 s[86:87], 0
  s_cbranch_scc1 Lpc_85
  v_max3_u32 v120, v128, v129, v130
  v_max_u32 v120, v120, v131
  v_cmp_eq_u32 s[86:87], -1, v120
Lpc_85:
  s_cmp_eq_u64 s[88:89], 0
  s_cbranch_scc1 Lpc_86
  v_max3_u32 v121, v132, v133, v134
  v_max_u32 v121, v121, v135
  v_cmp_eq_u32 s[88:89], -1, v121
Lpc_86:
  s_cmp_eq_u64 s[90:91], 0
  s_cbranch_scc1 Lpc_87
  v_max3_u32 v120, v136, v137, v138
  v_max_u32 v120, v120, v139
  v_cmp_eq_u32 s[90:91], -1, v120
Lpc_87:
  s_cmp_eq_u64 s[92:93], 0
  s_cbranch_scc1 Lpc_88
  v_max3_u32 v121, v140, v141, v142
  v_max_u32 v121, v121, v143
  v_cmp_eq_u32 s[92:93], -1, v121
Lpc_88:
  s_cmp_eq_u64 s[94:95], 0
  s_cbranch_scc1 Lpc_89
  v_max3_u32 v120, v144, v145, v146
  v_max_u32 v120, v120, v147
  v_cmp_eq_u32 s[94:95], -1, v120
Lpc_89:
  s_cmp_eq_u64 s[96:97], 0
  s_cbranch_scc1 Lpc_90
  v_max3_u32 v121, v148, v149, v150
  v_max_u32 v121, v121, v151
  v_cmp_eq_u32 s[96:97], -1, v121
Lpc_90:
  s_cmp_eq_u64 s[98:99], 0
  s_cbranch_scc1 Lpc_91
  v_max3_u32 v120, v152, v153, v154
  v_max_u32 v120, v120, v155
  v_cmp_eq_u32 s[98:99], -1, v120
Lpc_91:
  s_or_b64 s[84:85], s[86:87], s[88:89]
  s_or_b64 s[84:85], s[84:85], s[90:91]
  s_or_b64 s[84:85], s[84:85], s[92:93]
  s_or_b64 s[84:85], s[84:85], s[94:95]
  s_or_b64 s[84:85], s[84:85], s[96:97]
  s_or_b64 s[84:85], s[84:85], s[98:99]
  s_cmp_eq_u64 s[84:85], 0
  s_cbranch_scc1 Lpd_76
  s_sub_u32 s78, s78, 1
  s_cmp_lg_u32 s78, 0
  s_cbranch_scc1 Lpr_77
Lpd_76:
  v_pk_add_f32 v[128:129], v[128:129], v[144:145]
  v_pk_add_f32 v[130:131], v[130:131], v[146:147]
  v_pk_add_f32 v[132:133], v[132:133], v[148:149]
  v_pk_add_f32 v[134:135], v[134:135], v[150:151]
  v_pk_add_f32 v[136:137], v[136:137], v[152:153]
  v_pk_add_f32 v[138:139], v[138:139], v[154:155]
  v_pk_add_f32 v[128:129], v[128:129], v[136:137]
  v_pk_add_f32 v[130:131], v[130:131], v[138:139]
  v_pk_add_f32 v[132:133], v[132:133], v[140:141]
  v_pk_add_f32 v[134:135], v[134:135], v[142:143]
  v_pk_add_f32 v[128:129], v[128:129], v[132:133]
  v_pk_add_f32 v[130:131], v[130:131], v[134:135]
  s_nop 1
  v_permlane32_swap_b32 v128, v130
  v_permlane32_swap_b32 v129, v131
  v_add_f32 v128, v128, v130
  v_add_f32 v129, v129, v131
  s_nop 1
  v_permlane16_swap_b32 v128, v129
  s_nop 0
  v_add_f32 v128, v128, v129
  s_nop 1
  v_add_f32_dpp v128, v128, v128 row_ror:4 row_mask:0xf bank_mask:0xf
  s_nop 1
  v_add_f32_dpp v128, v128, v128 row_ror:8 row_mask:0xf bank_mask:0xf
  v_cvt_pk_bf16_f32 v128, 0, v128
  v_add_f32 v128, v128, v125
  v_cvt_pk_bf16_f32 v128, v128, v128
  s_mov_b32 exec_lo, 0x000f000f
  s_mov_b32 exec_hi, 0x000f000f
  buffer_store_short v128, v124, s[68:71], 0 offen sc1
  s_cmp_lg_u32 s4, 0
  s_cbranch_scc1 L_fin
  s_mov_b64 exec, 1
  buffer_store_dword v126, v2, s[40:43], 0 offen sc1
L_fin:
Lwe:
  s_mov_b64 exec, -1
L_end:
  s_endpgm
.section .rodata,"a"
.p2align 6
.amdhsa_kernel sequential_preLN__gqa_block_cached__glu_gated_reglu__decode_kernel
  .amdhsa_next_free_vgpr 512
  .amdhsa_next_free_sgpr 102
  .amdhsa_accum_offset 256
  .amdhsa_group_segment_fixed_size 0
  .amdhsa_kernarg_size 96
  .amdhsa_user_sgpr_count 2
  .amdhsa_user_sgpr_kernarg_segment_ptr 1
  .amdhsa_system_sgpr_workgroup_id_x 1
.end_amdhsa_kernel
```
